```python
import torch

def _softmax(x, axis=-1):
    return torch.softmax(x, dim=axis)
def _gelu(x):
    return torch.nn.functional.gelu(x, approximate="tanh")
def _silu(x):
    return torch.nn.functional.silu(x)
def _sigmoid(x):
    return torch.sigmoid(x)
def _layernorm(x, axis=-1, eps=1e-5):
    m = x.mean(dim=axis, keepdim=True)
    v = x.var(dim=axis, keepdim=True, unbiased=False)
    return (x - m) / torch.sqrt(v + eps)
def _scatter_add(tgt, idx, src, axis=0):
    return tgt.clone().index_add_(axis, idx, src)
def _segment_sum(src, seg, n):
    out = torch.zeros((n,) + src.shape[1:], dtype=src.dtype)
    return out.index_add_(0, seg, src)
def _pad(x, pw):
    flat = tuple(v for pair in reversed(pw) for v in pair)
    return torch.nn.functional.pad(x, flat)

kernel_name = 'recurrent_scan__softmax_full_mha__moe_arch_mod__prompt'

def setup_inputs():

    _w = (lambda a: (lambda t: t.to(torch.bfloat16) if t.is_floating_point() else t)(torch.as_tensor(a)))
    def _A_setup():
        B, S, D = 1, 2048, 1024
        return {
            "x": _w((lambda *s: torch.randn(*s, dtype=torch.bfloat16) * 0.05)(B, S, D)),
            "wqkv": _w((lambda *s: torch.randn(*s, dtype=torch.bfloat16) * 0.05)(D, 3 * D)),
            "wo": _w((lambda *s: torch.randn(*s, dtype=torch.bfloat16) * 0.05)(D, D)),
        }
    _A_in = _A_setup()

    def _B_setup():
        B, S, D, F, C = 1, 2048, 1024, 3584, 8
        return {
            "x": _w((lambda *s: torch.randn(*s, dtype=torch.bfloat16) * 0.05)(B, S, D)),
            "w_r": _w((lambda *s: torch.randn(*s, dtype=torch.bfloat16) * 0.05)(D)),
            "w_gate": _w((lambda *s: torch.randn(*s, dtype=torch.bfloat16) * 0.05)(D, F)),
            "w_up": _w((lambda *s: torch.randn(*s, dtype=torch.bfloat16) * 0.05)(D, F)),
            "w_down": _w((lambda *s: torch.randn(*s, dtype=torch.bfloat16) * 0.05)(F, D)),
        }
    _B_in = _B_setup()

    return {
        "A_x": _A_in["x"],
        "A_wqkv": _A_in["wqkv"],
        "A_wo": _A_in["wo"],
        "B_x": _B_in["x"],
        "B_w_r": _B_in["w_r"],
        "B_w_gate": _B_in["w_gate"],
        "B_w_up": _B_in["w_up"],
        "B_w_down": _B_in["w_down"],
    }

def reference(A_x, A_wqkv, A_wo, B_x, B_w_r, B_w_gate, B_w_up, B_w_down):
    def _A_ref(x, wqkv, wo):
        B, S, D = x.shape
        H = 32; Dh = D // H
        qkv = (lambda x, *d: x.permute(*d))((x @ wqkv).reshape(B, S, 3, H, Dh), 2, 0, 3, 1, 4)
        q, k, v = qkv[0], qkv[1], qkv[2]
        scale = Dh ** -0.5
        scores = torch.einsum("bhqd,bhkd->bhqk", q, k) * scale
        p = _softmax(scores, axis=-1)
        o = torch.einsum("bhqk,bhkd->bhqd", p, v)
        return (lambda x, *d: x.permute(*d))(o, 0, 2, 1, 3).reshape(B, S, D) @ wo

    def _B_ref(x, w_r, w_gate, w_up, w_down):
        B, S, D = x.shape
        C = 8
        r = x @ w_r
        idx = torch.argsort(-r, axis=-1)[:, :C]
        idx_e = (lambda x, n, axis: torch.repeat_interleave(x, n, dim=axis))(idx.reshape(B, C, 1), D, axis=2)
        x_sel = (lambda x, i, axis: torch.take_along_dim(x, i, dim=axis))(x, idx_e, axis=1)
        g = _silu(x_sel @ w_gate)
        u = x_sel @ w_up
        y = (g * u) @ w_down
        r_sel = _sigmoid((lambda x, i, axis: torch.take_along_dim(x, i, dim=axis))(r, idx, axis=1))
        y = y * r_sel.reshape(B, C, 1)
        b_off = (torch.arange(B) * S).reshape(B, 1)
        flat_idx = (idx + b_off).reshape(B * C)
        zero = (x * 0.0).reshape(B * S, D)
        upd = _scatter_add(zero, flat_idx, y.reshape(B * C, D), axis=0)
        return x + upd.reshape(B, S, D)

    x = A_x
    xn = _layernorm(x, axis=-1)
    s = _A_ref(xn, A_wqkv, A_wo)
    g = _silu(_B_ref(xn, B_w_r, B_w_gate, B_w_up, B_w_down))
    return x + s * g
```

```asm
; @launch grid=(256,1,1) block=(768,1,1) lds=163840
.amdgcn_target "amdgcn-amd-amdhsa--gfx950"
.text
.globl recurrent_scan__softmax_full_mha__moe_arch_mod__prompt_kernel
.p2align 8
.type recurrent_scan__softmax_full_mha__moe_arch_mod__prompt_kernel,@function
recurrent_scan__softmax_full_mha__moe_arch_mod__prompt_kernel:
    s_cmp_ge_u32 s2, 256
    s_cbranch_scc1 L_end
L_c_start:
    v_mov_b32 v91, 0x7ffffff0
    s_load_dwordx4 s[4:7], s[0:1], 0
    s_load_dwordx2 s[42:43], s[0:1], 32
    s_load_dwordx4 s[44:47], s[0:1], 72
    v_lshrrev_b32 v17, 6, v0
    v_and_b32 v1, 63, v0
    v_readfirstlane_b32 s22, v17
    s_and_b32 s30, s2, 7
    s_lshr_b32 s31, s2, 3

    s_and_b32 s32, s30, 1
    s_lshl_b32 s32, s32, 3
    s_and_b32 s33, s31, 7
    s_add_u32 s32, s32, s33
    s_lshr_b32 s33, s30, 1
    s_lshl_b32 s33, s33, 2
    s_lshr_b32 s34, s31, 3
    s_add_u32 s33, s33, s34
    s_add_u32 s48, s32, s33
    s_and_b32 s48, s48, 3
    s_lshl_b32 s48, s48, 2
    s_cmp_ge_u32 s22, 8
    s_cbranch_scc1 L_aux
    s_cmp_ge_u32 s22, 6
    s_cbranch_scc1 L_stats
    s_cmp_ge_u32 s22, 4
    s_cbranch_scc1 L_dma
    s_lshr_b32 s36, s22, 1
    s_and_b32 s37, s22, 1
    s_mul_i32 s35, s36, 20480
    v_and_b32 v18, 31, v1
    v_lshlrev_b32 v18, 7, v18
    v_add_u32 v18, s35, v18
    v_lshrrev_b32 v19, 5, v1
    v_bfe_u32 v20, v1, 1, 3
    v_xor_b32 v20, v19, v20
    v_xor_b32 v21, 0, v20
    v_lshl_add_u32 v12, v21, 4, v18
    v_xor_b32 v21, 2, v20
    v_lshl_add_u32 v13, v21, 4, v18
    v_xor_b32 v21, 4, v20
    v_lshl_add_u32 v14, v21, 4, v18
    v_xor_b32 v21, 6, v20
    v_lshl_add_u32 v15, v21, 4, v18
    v_bfe_u32 v18, v1, 2, 2
    v_lshl_add_u32 v21, v19, 3, v18
    v_lshlrev_b32 v21, 7, v21
    v_bfe_u32 v22, v1, 4, 1
    v_bfe_u32 v23, v1, 1, 1
    v_lshl_add_u32 v22, v22, 1, v23
    s_lshl_b32 s35, s37, 2
    v_add_u32 v22, s35, v22
    v_lshrrev_b32 v18, 1, v18
    v_lshlrev_b32 v18, 2, v18
    v_xor_b32 v22, v22, v18
    v_lshl_add_u32 v21, v22, 4, v21
    v_and_b32 v22, 1, v1
    v_lshl_add_u32 v21, v22, 3, v21
    v_add_u32 v16, 4096, v21
    s_mov_b32 s56, 0
    s_waitcnt lgkmcnt(0)
    s_add_u32 s16, s46, 4194304
    s_addc_u32 s17, s47, 0
    s_mov_b32 s18, 12582912
    s_mov_b32 s19, 0x20000
    s_add_u32 s24, s46, 20971520
    s_addc_u32 s25, s47, 0
    s_mov_b32 s26, 1048576
    s_mov_b32 s27, 0x20000
    v_and_b32 v2, 31, v1
    s_lshl_b32 s35, s36, 6
    v_add_u32 v3, s35, v2
    v_lshlrev_b32 v3, 2, v3
    v_add_u32 v3, 139264, v3
    s_lshl_b32 s35, s37, 5
    v_add_u32 v4, s35, v2
    v_lshlrev_b32 v4, 2, v4
    v_add_u32 v4, 140800, v4
    v_lshlrev_b32 v5, 4, v19
    s_lshl_b32 s35, s37, 7
    v_add_u32 v6, s35, v5
    v_add_u32 v6, 140288, v6
    s_lshl_b32 s35, s36, 8
    v_add_u32 v7, s35, v5
    v_add_u32 v7, 139264, v7
    s_add_u32 s40, s33, 0
    s_and_b32 s40, s40, 15
    s_lshl_b32 s40, s40, 1
    s_add_u32 s40, s40, s37
    s_mul_i32 s41, s40, 6144
    s_lshl_b32 s38, s32, 7
    s_add_u32 s41, s41, s38
    s_lshl_b32 s38, s36, 2
    s_add_u32 s41, s41, s38
    s_add_u32 s49, s41, 491520
    s_lshl_b32 s40, s40, 6
    s_lshl_b32 s41, s32, 2
    s_add_u32 s40, s40, s41
    s_lshl_b32 s41, s36, 1
    s_add_u32 s40, s40, s41
    s_lshl_b32 s34, s40, 11
    s_add_u32 s40, s33, 3
    s_and_b32 s40, s40, 15
    s_lshl_b32 s40, s40, 1
    s_add_u32 s40, s40, s37
    s_mul_i32 s41, s40, 6144
    s_lshl_b32 s38, s32, 7
    s_add_u32 s41, s41, s38
    s_lshl_b32 s38, s36, 2
    s_add_u32 s41, s41, s38
    s_add_u32 s50, s41, 493568
    s_lshl_b32 s40, s40, 6
    s_lshl_b32 s41, s32, 2
    s_add_u32 s40, s40, s41
    s_lshl_b32 s41, s36, 1
    s_add_u32 s40, s40, s41
    s_lshl_b32 s35, s40, 12
    s_add_u32 s40, s33, 6
    s_and_b32 s40, s40, 15
    s_lshl_b32 s40, s40, 1
    s_add_u32 s40, s40, s37
    s_mul_i32 s41, s40, 6144
    s_lshl_b32 s38, s32, 7
    s_add_u32 s41, s41, s38
    s_lshl_b32 s38, s36, 2
    s_add_u32 s41, s41, s38
    s_add_u32 s51, s41, 495616
    s_lshl_b32 s40, s40, 6
    s_lshl_b32 s41, s32, 2
    s_add_u32 s40, s40, s41
    s_lshl_b32 s41, s36, 1
    s_add_u32 s40, s40, s41
    s_lshl_b32 s39, s40, 12
    s_add_u32 s35, s35, 4194304
    s_add_u32 s39, s39, 4196352
    s_add_u32 s40, s35, 4096
    s_add_u32 s41, s39, 4096
    v_and_b32 v2, 0x33, v1
    v_bfe_u32 v8, v1, 2, 1
    v_lshl_or_b32 v2, v8, 3, v2
    v_bfe_u32 v8, v1, 3, 1
    v_lshl_or_b32 v2, v8, 2, v2
    v_lshlrev_b32 v2, 4, v2
    v_lshlrev_b32 v30, 4, v1
    s_mov_b32 s38, 0x3e8293ee
    v_mov_b32 v31, s49
    v_writelane_b32 v31, s50, 1
    v_writelane_b32 v31, s51, 2
    v_mov_b32 v32, 0
    v_mov_b32 v33, 0
    v_mov_b32 v34, 0
    v_mov_b32 v35, 0
    v_mov_b32 v36, 0
    v_mov_b32 v37, 0
    v_mov_b32 v38, 0
    v_mov_b32 v39, 0
    v_mov_b32 v40, 0
    v_mov_b32 v41, 0
    v_mov_b32 v42, 0
    v_mov_b32 v43, 0
    v_mov_b32 v44, 0
    v_mov_b32 v45, 0
    v_mov_b32 v46, 0
    v_mov_b32 v47, 0
    v_mov_b32 v48, 0
    v_mov_b32 v49, 0
    v_mov_b32 v50, 0
    v_mov_b32 v51, 0
    v_mov_b32 v52, 0
    v_mov_b32 v53, 0
    v_mov_b32 v54, 0
    v_mov_b32 v55, 0
    v_mov_b32 v56, 0
    v_mov_b32 v57, 0
    v_mov_b32 v58, 0
    v_mov_b32 v59, 0
    v_mov_b32 v60, 0
    v_mov_b32 v61, 0
    v_mov_b32 v62, 0
    v_mov_b32 v63, 0
    v_mov_b32 v64, 0
    v_mov_b32 v65, 0
    v_mov_b32 v66, 0
    v_mov_b32 v67, 0
    v_mov_b32 v68, 0
    v_mov_b32 v69, 0
    v_mov_b32 v70, 0
    v_mov_b32 v71, 0
    v_mov_b32 v72, 0
    v_mov_b32 v73, 0
    v_mov_b32 v74, 0
    v_mov_b32 v75, 0
    v_mov_b32 v76, 0
    v_mov_b32 v77, 0
    v_mov_b32 v78, 0
    v_mov_b32 v79, 0
    v_mov_b32 v80, 0
    v_mov_b32 v81, 0
    v_mov_b32 v82, 0
    v_mov_b32 v83, 0
    v_mov_b32 v84, 0
    v_mov_b32 v85, 0
    v_mov_b32 v86, 0
    v_mov_b32 v87, 0
    v_mov_b32 v88, 0
    v_mov_b32 v89, 0
    v_mov_b32 v90, 0
    v_mov_b32 v91, 0
    v_mov_b32 v92, 0
    v_mov_b32 v93, 0
    v_mov_b32 v94, 0
    v_mov_b32 v95, 0
    v_mov_b32 v96, 0
    v_mov_b32 v97, 0
    v_mov_b32 v98, 0
    v_mov_b32 v99, 0
    v_mov_b32 v100, 0
    v_mov_b32 v101, 0
    v_mov_b32 v102, 0
    v_mov_b32 v103, 0
    v_mov_b32 v104, 0
    v_mov_b32 v105, 0
    v_mov_b32 v106, 0
    v_mov_b32 v107, 0
    v_mov_b32 v108, 0
    v_mov_b32 v109, 0
    v_mov_b32 v110, 0
    v_mov_b32 v111, 0
    v_mov_b32 v112, 0
    v_mov_b32 v113, 0
    v_mov_b32 v114, 0
    v_mov_b32 v115, 0
    v_mov_b32 v116, 0
    v_mov_b32 v117, 0
    v_mov_b32 v118, 0
    v_mov_b32 v119, 0
    v_mov_b32 v120, 0
    v_mov_b32 v121, 0
    v_mov_b32 v122, 0
    v_mov_b32 v123, 0
    v_mov_b32 v124, 0
    v_mov_b32 v125, 0
    v_mov_b32 v126, 0
    v_mov_b32 v127, 0
    v_mov_b32 v148, 0
    v_mov_b32 v149, 0
    v_mov_b32 v150, 0
    v_mov_b32 v151, 0
    v_mov_b32 v152, 0
    v_mov_b32 v153, 0
    v_mov_b32 v154, 0
    v_mov_b32 v155, 0
    v_mov_b32 v156, 0
    v_mov_b32 v157, 0
    v_mov_b32 v158, 0
    v_mov_b32 v159, 0
    v_mov_b32 v160, 0
    v_mov_b32 v161, 0
    v_mov_b32 v162, 0
    v_mov_b32 v163, 0
    v_mov_b32 v164, 0
    v_mov_b32 v165, 0
    v_mov_b32 v166, 0
    v_mov_b32 v167, 0
    s_barrier
    s_waitcnt lgkmcnt(0)
    s_mov_b32 s55, 15
    .p2align 6
L_p1_loop:
    v_mfma_f32_32x32x16_bf16 v[32:47], v[156:159], v[148:151], v[32:47]
    ds_read_b128 v[128:131], v12 offset:0
    ds_read_b64_tr_b16 v[136:137], v16 offset:0
    v_mfma_f32_32x32x16_bf16 v[48:63], v[156:159], v[152:155], v[48:63]
    ds_read_b64_tr_b16 v[138:139], v16 offset:512
    ds_read_b128 v[132:135], v12 offset:10240
    v_mfma_f32_32x32x16_bf16 v[64:79], v[160:163], v[148:151], v[64:79]
    ds_read_b64_tr_b16 v[140:141], v16 offset:2048
    ds_read_b64_tr_b16 v[142:143], v16 offset:2560
    v_mfma_f32_32x32x16_bf16 v[80:95], v[160:163], v[152:155], v[80:95]
    ds_read_b64_tr_b16 v[144:145], v16 offset:4096
    ds_read_b64_tr_b16 v[146:147], v16 offset:4608
    v_mfma_f32_32x32x16_bf16 v[96:111], v[148:151], v[164:167], v[96:111]
    s_add_u32 s57, s56, 40960
    s_cmp_eq_u32 s57, 122880
    s_cselect_b32 s57, 0, s57
    s_sub_u32 s54, s57, s56
    s_mov_b32 s56, s57
    v_mfma_f32_32x32x16_bf16 v[112:127], v[152:155], v[164:167], v[112:127]
    v_add_u32 v12, s54, v12
    s_waitcnt lgkmcnt(0)
    v_mfma_f32_32x32x16_bf16 v[32:47], v[136:139], v[128:131], v[32:47]
    ds_read_b128 v[148:151], v13 offset:0
    ds_read_b64_tr_b16 v[156:157], v16 offset:10240
    v_mfma_f32_32x32x16_bf16 v[48:63], v[136:139], v[132:135], v[48:63]
    ds_read_b64_tr_b16 v[158:159], v16 offset:10752
    ds_read_b128 v[152:155], v13 offset:10240
    v_mfma_f32_32x32x16_bf16 v[64:79], v[140:143], v[128:131], v[64:79]
    ds_read_b64_tr_b16 v[160:161], v16 offset:12288
    ds_read_b64_tr_b16 v[162:163], v16 offset:12800
    v_mfma_f32_32x32x16_bf16 v[80:95], v[140:143], v[132:135], v[80:95]
    ds_read_b64_tr_b16 v[164:165], v16 offset:14336
    ds_read_b64_tr_b16 v[166:167], v16 offset:14848
    v_mfma_f32_32x32x16_bf16 v[96:111], v[128:131], v[144:147], v[96:111]
    v_add_u32 v13, s54, v13
    v_mfma_f32_32x32x16_bf16 v[112:127], v[132:135], v[144:147], v[112:127]
    s_sub_u32 s55, s55, 1
    s_cmp_lg_u32 s55, 0
    s_waitcnt lgkmcnt(0)
    v_mfma_f32_32x32x16_bf16 v[32:47], v[156:159], v[148:151], v[32:47]
    ds_read_b128 v[128:131], v14 offset:0
    ds_read_b64_tr_b16 v[136:137], v16 offset:20480
    v_mfma_f32_32x32x16_bf16 v[48:63], v[156:159], v[152:155], v[48:63]
    ds_read_b64_tr_b16 v[138:139], v16 offset:20992
    ds_read_b128 v[132:135], v14 offset:10240
    v_mfma_f32_32x32x16_bf16 v[64:79], v[160:163], v[148:151], v[64:79]
    ds_read_b64_tr_b16 v[140:141], v16 offset:22528
    ds_read_b64_tr_b16 v[142:143], v16 offset:23040
    v_mfma_f32_32x32x16_bf16 v[80:95], v[160:163], v[152:155], v[80:95]
    ds_read_b64_tr_b16 v[144:145], v16 offset:24576
    ds_read_b64_tr_b16 v[146:147], v16 offset:25088
    v_mfma_f32_32x32x16_bf16 v[96:111], v[148:151], v[164:167], v[96:111]
    v_add_u32 v14, s54, v14
    v_mfma_f32_32x32x16_bf16 v[112:127], v[152:155], v[164:167], v[112:127]
    s_waitcnt lgkmcnt(0)
    v_mfma_f32_32x32x16_bf16 v[32:47], v[136:139], v[128:131], v[32:47]
    ds_read_b128 v[148:151], v15 offset:0
    ds_read_b64_tr_b16 v[156:157], v16 offset:30720
    ds_read_b64_tr_b16 v[158:159], v16 offset:31232
    v_mfma_f32_32x32x16_bf16 v[48:63], v[136:139], v[132:135], v[48:63]
    ds_read_b128 v[152:155], v15 offset:10240
    ds_read_b64_tr_b16 v[160:161], v16 offset:32768
    ds_read_b64_tr_b16 v[162:163], v16 offset:33280
    v_mfma_f32_32x32x16_bf16 v[64:79], v[140:143], v[128:131], v[64:79]
    ds_read_b64_tr_b16 v[164:165], v16 offset:34816
    ds_read_b64_tr_b16 v[166:167], v16 offset:35328
    v_mfma_f32_32x32x16_bf16 v[80:95], v[140:143], v[132:135], v[80:95]
    v_add_u32 v15, s54, v15
    v_add_u32 v16, s54, v16
    v_mfma_f32_32x32x16_bf16 v[96:111], v[128:131], v[144:147], v[96:111]
    s_waitcnt lgkmcnt(0)
    s_barrier
    v_mfma_f32_32x32x16_bf16 v[112:127], v[132:135], v[144:147], v[112:127]
    s_cbranch_scc1 L_p1_loop
    v_mfma_f32_32x32x16_bf16 v[32:47], v[156:159], v[148:151], v[32:47]
    ds_read_b128 v[128:131], v12 offset:0
    ds_read_b64_tr_b16 v[136:137], v16 offset:0
    v_mfma_f32_32x32x16_bf16 v[48:63], v[156:159], v[152:155], v[48:63]
    ds_read_b64_tr_b16 v[138:139], v16 offset:512
    ds_read_b128 v[132:135], v12 offset:10240
    v_mfma_f32_32x32x16_bf16 v[64:79], v[160:163], v[148:151], v[64:79]
    ds_read_b64_tr_b16 v[140:141], v16 offset:2048
    ds_read_b64_tr_b16 v[142:143], v16 offset:2560
    v_mfma_f32_32x32x16_bf16 v[80:95], v[160:163], v[152:155], v[80:95]
    ds_read_b64_tr_b16 v[144:145], v16 offset:4096
    ds_read_b64_tr_b16 v[146:147], v16 offset:4608
    v_mfma_f32_32x32x16_bf16 v[96:111], v[148:151], v[164:167], v[96:111]
    v_mfma_f32_32x32x16_bf16 v[112:127], v[152:155], v[164:167], v[112:127]
    s_waitcnt lgkmcnt(0)
    v_mfma_f32_32x32x16_bf16 v[32:47], v[136:139], v[128:131], v[32:47]
    ds_read_b128 v[148:151], v13 offset:0
    ds_read_b64_tr_b16 v[156:157], v16 offset:10240
    v_mfma_f32_32x32x16_bf16 v[48:63], v[136:139], v[132:135], v[48:63]
    ds_read_b64_tr_b16 v[158:159], v16 offset:10752
    ds_read_b128 v[152:155], v13 offset:10240
    v_mfma_f32_32x32x16_bf16 v[64:79], v[140:143], v[128:131], v[64:79]
    ds_read_b64_tr_b16 v[160:161], v16 offset:12288
    ds_read_b64_tr_b16 v[162:163], v16 offset:12800
    v_mfma_f32_32x32x16_bf16 v[80:95], v[140:143], v[132:135], v[80:95]
    ds_read_b64_tr_b16 v[164:165], v16 offset:14336
    ds_read_b64_tr_b16 v[166:167], v16 offset:14848
    v_mfma_f32_32x32x16_bf16 v[96:111], v[128:131], v[144:147], v[96:111]
    v_mfma_f32_32x32x16_bf16 v[112:127], v[132:135], v[144:147], v[112:127]
    s_waitcnt lgkmcnt(0)
    v_mfma_f32_32x32x16_bf16 v[32:47], v[156:159], v[148:151], v[32:47]
    ds_read_b128 v[128:131], v14 offset:0
    ds_read_b64_tr_b16 v[136:137], v16 offset:20480
    v_mfma_f32_32x32x16_bf16 v[48:63], v[156:159], v[152:155], v[48:63]
    ds_read_b64_tr_b16 v[138:139], v16 offset:20992
    ds_read_b128 v[132:135], v14 offset:10240
    v_mfma_f32_32x32x16_bf16 v[64:79], v[160:163], v[148:151], v[64:79]
    ds_read_b64_tr_b16 v[140:141], v16 offset:22528
    ds_read_b64_tr_b16 v[142:143], v16 offset:23040
    v_mfma_f32_32x32x16_bf16 v[80:95], v[160:163], v[152:155], v[80:95]
    ds_read_b64_tr_b16 v[144:145], v16 offset:24576
    ds_read_b64_tr_b16 v[146:147], v16 offset:25088
    v_mfma_f32_32x32x16_bf16 v[96:111], v[148:151], v[164:167], v[96:111]
    v_mfma_f32_32x32x16_bf16 v[112:127], v[152:155], v[164:167], v[112:127]
    s_waitcnt lgkmcnt(0)
    v_mfma_f32_32x32x16_bf16 v[32:47], v[136:139], v[128:131], v[32:47]
    ds_read_b128 v[148:151], v15 offset:0
    ds_read_b64_tr_b16 v[156:157], v16 offset:30720
    v_mfma_f32_32x32x16_bf16 v[48:63], v[136:139], v[132:135], v[48:63]
    ds_read_b64_tr_b16 v[158:159], v16 offset:31232
    ds_read_b128 v[152:155], v15 offset:10240
    v_mfma_f32_32x32x16_bf16 v[64:79], v[140:143], v[128:131], v[64:79]
    ds_read_b64_tr_b16 v[160:161], v16 offset:32768
    ds_read_b64_tr_b16 v[162:163], v16 offset:33280
    v_mfma_f32_32x32x16_bf16 v[80:95], v[140:143], v[132:135], v[80:95]
    ds_read_b64_tr_b16 v[164:165], v16 offset:34816
    ds_read_b64_tr_b16 v[166:167], v16 offset:35328
    v_mfma_f32_32x32x16_bf16 v[96:111], v[128:131], v[144:147], v[96:111]
    v_mfma_f32_32x32x16_bf16 v[112:127], v[132:135], v[144:147], v[112:127]
L_c_epi:
    s_waitcnt lgkmcnt(0)
    v_mfma_f32_32x32x16_bf16 v[32:47], v[156:159], v[148:151], v[32:47]
    ds_read_b32 v144, v3
    ds_read_b32 v145, v3 offset:512
    ds_read_b32 v146, v3 offset:128
    ds_read_b32 v147, v3 offset:640
    v_mfma_f32_32x32x16_bf16 v[48:63], v[156:159], v[152:155], v[48:63]
    ds_read_b128 v[128:131], v6 offset:0
    ds_read_b128 v[132:135], v6 offset:32
    v_mfma_f32_32x32x16_bf16 v[64:79], v[160:163], v[148:151], v[64:79]
    ds_read_b128 v[136:139], v6 offset:64
    ds_read_b128 v[140:143], v6 offset:96
    v_mfma_f32_32x32x16_bf16 v[80:95], v[160:163], v[152:155], v[80:95]
    ds_read_b32 v5, v4
    v_mfma_f32_32x32x16_bf16 v[96:111], v[148:151], v[164:167], v[96:111]
    v_mfma_f32_32x32x16_bf16 v[112:127], v[152:155], v[164:167], v[112:127]
    s_waitcnt lgkmcnt(5)
    v_mul_f32 v8, s38, v144
    v_mul_f32 v9, s38, v145
    v_mul_f32 v10, s38, v146
    v_mul_f32 v11, s38, v147
    ds_read_b128 v[148:151], v6 offset:256
    ds_read_b128 v[152:155], v6 offset:288
    ds_read_b128 v[156:159], v6 offset:320
    ds_read_b128 v[160:163], v6 offset:352
    s_waitcnt lgkmcnt(4)
    v_pk_mul_f32 v[28:29], v[128:129], v[8:9] op_sel:[0,1] op_sel_hi:[1,1]
    v_pk_fma_f32 v[32:33], v[32:33], v[8:9], v[28:29] op_sel_hi:[1,0,1] neg_lo:[0,0,1] neg_hi:[0,0,1]
    v_pk_mul_f32 v[28:29], v[130:131], v[8:9] op_sel:[0,1] op_sel_hi:[1,1]
    v_pk_fma_f32 v[34:35], v[34:35], v[8:9], v[28:29] op_sel_hi:[1,0,1] neg_lo:[0,0,1] neg_hi:[0,0,1]
    v_pk_mul_f32 v[28:29], v[132:133], v[8:9] op_sel:[0,1] op_sel_hi:[1,1]
    v_pk_fma_f32 v[36:37], v[36:37], v[8:9], v[28:29] op_sel_hi:[1,0,1] neg_lo:[0,0,1] neg_hi:[0,0,1]
    v_pk_mul_f32 v[28:29], v[134:135], v[8:9] op_sel:[0,1] op_sel_hi:[1,1]
    v_pk_fma_f32 v[38:39], v[38:39], v[8:9], v[28:29] op_sel_hi:[1,0,1] neg_lo:[0,0,1] neg_hi:[0,0,1]
    v_pk_mul_f32 v[28:29], v[136:137], v[8:9] op_sel:[0,1] op_sel_hi:[1,1]
    v_pk_fma_f32 v[40:41], v[40:41], v[8:9], v[28:29] op_sel_hi:[1,0,1] neg_lo:[0,0,1] neg_hi:[0,0,1]
    v_pk_mul_f32 v[28:29], v[138:139], v[8:9] op_sel:[0,1] op_sel_hi:[1,1]
    v_pk_fma_f32 v[42:43], v[42:43], v[8:9], v[28:29] op_sel_hi:[1,0,1] neg_lo:[0,0,1] neg_hi:[0,0,1]
    v_pk_mul_f32 v[28:29], v[140:141], v[8:9] op_sel:[0,1] op_sel_hi:[1,1]
    v_pk_fma_f32 v[44:45], v[44:45], v[8:9], v[28:29] op_sel_hi:[1,0,1] neg_lo:[0,0,1] neg_hi:[0,0,1]
    v_pk_mul_f32 v[28:29], v[142:143], v[8:9] op_sel:[0,1] op_sel_hi:[1,1]
    v_pk_fma_f32 v[46:47], v[46:47], v[8:9], v[28:29] op_sel_hi:[1,0,1] neg_lo:[0,0,1] neg_hi:[0,0,1]
    v_cvt_pk_bf16_f32 v20, v32, v33
    v_cvt_pk_bf16_f32 v21, v34, v35
    v_cvt_pk_bf16_f32 v22, v36, v37
    v_cvt_pk_bf16_f32 v23, v38, v39
    v_cvt_pk_bf16_f32 v24, v40, v41
    v_cvt_pk_bf16_f32 v25, v42, v43
    v_cvt_pk_bf16_f32 v26, v44, v45
    v_cvt_pk_bf16_f32 v27, v46, v47
    buffer_store_dwordx4 v[20:23], v30, s[16:19], s34 offen offset:0 sc1
    buffer_store_dwordx4 v[24:27], v30, s[16:19], s34 offen offset:1024 sc1
    v_pk_mul_f32 v[28:29], v[128:129], v[10:11] op_sel:[0,1] op_sel_hi:[1,1]
    v_pk_fma_f32 v[48:49], v[48:49], v[10:11], v[28:29] op_sel_hi:[1,0,1] neg_lo:[0,0,1] neg_hi:[0,0,1]
    v_pk_mul_f32 v[28:29], v[130:131], v[10:11] op_sel:[0,1] op_sel_hi:[1,1]
    v_pk_fma_f32 v[50:51], v[50:51], v[10:11], v[28:29] op_sel_hi:[1,0,1] neg_lo:[0,0,1] neg_hi:[0,0,1]
    v_pk_mul_f32 v[28:29], v[132:133], v[10:11] op_sel:[0,1] op_sel_hi:[1,1]
    v_pk_fma_f32 v[52:53], v[52:53], v[10:11], v[28:29] op_sel_hi:[1,0,1] neg_lo:[0,0,1] neg_hi:[0,0,1]
    v_pk_mul_f32 v[28:29], v[134:135], v[10:11] op_sel:[0,1] op_sel_hi:[1,1]
    v_pk_fma_f32 v[54:55], v[54:55], v[10:11], v[28:29] op_sel_hi:[1,0,1] neg_lo:[0,0,1] neg_hi:[0,0,1]
    v_pk_mul_f32 v[28:29], v[136:137], v[10:11] op_sel:[0,1] op_sel_hi:[1,1]
    v_pk_fma_f32 v[56:57], v[56:57], v[10:11], v[28:29] op_sel_hi:[1,0,1] neg_lo:[0,0,1] neg_hi:[0,0,1]
    v_pk_mul_f32 v[28:29], v[138:139], v[10:11] op_sel:[0,1] op_sel_hi:[1,1]
    v_pk_fma_f32 v[58:59], v[58:59], v[10:11], v[28:29] op_sel_hi:[1,0,1] neg_lo:[0,0,1] neg_hi:[0,0,1]
    v_pk_mul_f32 v[28:29], v[140:141], v[10:11] op_sel:[0,1] op_sel_hi:[1,1]
    v_pk_fma_f32 v[60:61], v[60:61], v[10:11], v[28:29] op_sel_hi:[1,0,1] neg_lo:[0,0,1] neg_hi:[0,0,1]
    v_pk_mul_f32 v[28:29], v[142:143], v[10:11] op_sel:[0,1] op_sel_hi:[1,1]
    v_pk_fma_f32 v[62:63], v[62:63], v[10:11], v[28:29] op_sel_hi:[1,0,1] neg_lo:[0,0,1] neg_hi:[0,0,1]
    v_cvt_pk_bf16_f32 v12, v48, v49
    v_cvt_pk_bf16_f32 v13, v50, v51
    v_cvt_pk_bf16_f32 v14, v52, v53
    v_cvt_pk_bf16_f32 v15, v54, v55
    v_cvt_pk_bf16_f32 v16, v56, v57
    v_cvt_pk_bf16_f32 v17, v58, v59
    v_cvt_pk_bf16_f32 v18, v60, v61
    v_cvt_pk_bf16_f32 v19, v62, v63
    buffer_store_dwordx4 v[12:15], v30, s[16:19], s34 offen offset:2048 sc1
    buffer_store_dwordx4 v[16:19], v30, s[16:19], s34 offen offset:3072 sc1
    s_waitcnt lgkmcnt(0)
    ds_read_b128 v[32:35], v7 offset:0
    ds_read_b128 v[48:51], v7 offset:512
    ds_read_b128 v[36:39], v7 offset:32
    ds_read_b128 v[52:55], v7 offset:544
    ds_read_b128 v[40:43], v7 offset:64
    ds_read_b128 v[56:59], v7 offset:576
    ds_read_b128 v[44:47], v7 offset:96
    ds_read_b128 v[60:63], v7 offset:608
    v_pk_mul_f32 v[28:29], v[148:149], v[144:145] op_sel:[0,1] op_sel_hi:[1,1]
    v_pk_fma_f32 v[64:65], v[64:65], v[144:145], v[28:29] op_sel_hi:[1,0,1] neg_lo:[0,0,1] neg_hi:[0,0,1]
    v_pk_mul_f32 v[28:29], v[150:151], v[144:145] op_sel:[0,1] op_sel_hi:[1,1]
    v_pk_fma_f32 v[66:67], v[66:67], v[144:145], v[28:29] op_sel_hi:[1,0,1] neg_lo:[0,0,1] neg_hi:[0,0,1]
    v_pk_mul_f32 v[28:29], v[152:153], v[144:145] op_sel:[0,1] op_sel_hi:[1,1]
    v_pk_fma_f32 v[68:69], v[68:69], v[144:145], v[28:29] op_sel_hi:[1,0,1] neg_lo:[0,0,1] neg_hi:[0,0,1]
    v_pk_mul_f32 v[28:29], v[154:155], v[144:145] op_sel:[0,1] op_sel_hi:[1,1]
    v_pk_fma_f32 v[70:71], v[70:71], v[144:145], v[28:29] op_sel_hi:[1,0,1] neg_lo:[0,0,1] neg_hi:[0,0,1]
    v_pk_mul_f32 v[28:29], v[156:157], v[144:145] op_sel:[0,1] op_sel_hi:[1,1]
    v_pk_fma_f32 v[72:73], v[72:73], v[144:145], v[28:29] op_sel_hi:[1,0,1] neg_lo:[0,0,1] neg_hi:[0,0,1]
    v_pk_mul_f32 v[28:29], v[158:159], v[144:145] op_sel:[0,1] op_sel_hi:[1,1]
    v_pk_fma_f32 v[74:75], v[74:75], v[144:145], v[28:29] op_sel_hi:[1,0,1] neg_lo:[0,0,1] neg_hi:[0,0,1]
    v_pk_mul_f32 v[28:29], v[160:161], v[144:145] op_sel:[0,1] op_sel_hi:[1,1]
    v_pk_fma_f32 v[76:77], v[76:77], v[144:145], v[28:29] op_sel_hi:[1,0,1] neg_lo:[0,0,1] neg_hi:[0,0,1]
    v_pk_mul_f32 v[28:29], v[162:163], v[144:145] op_sel:[0,1] op_sel_hi:[1,1]
    v_pk_fma_f32 v[78:79], v[78:79], v[144:145], v[28:29] op_sel_hi:[1,0,1] neg_lo:[0,0,1] neg_hi:[0,0,1]
    v_cvt_pk_bf16_f32 v20, v64, v65
    v_cvt_pk_bf16_f32 v21, v66, v67
    v_cvt_pk_bf16_f32 v22, v68, v69
    v_cvt_pk_bf16_f32 v23, v70, v71
    v_cvt_pk_bf16_f32 v24, v72, v73
    v_cvt_pk_bf16_f32 v25, v74, v75
    v_cvt_pk_bf16_f32 v26, v76, v77
    v_cvt_pk_bf16_f32 v27, v78, v79
    buffer_store_dwordx4 v[20:23], v2, s[16:19], s35 offen offset:0 sc1
    buffer_store_dwordx4 v[24:27], v2, s[16:19], s35 offen offset:1024 sc1
    v_pk_mul_f32 v[28:29], v[148:149], v[146:147] op_sel:[0,1] op_sel_hi:[1,1]
    v_pk_fma_f32 v[80:81], v[80:81], v[146:147], v[28:29] op_sel_hi:[1,0,1] neg_lo:[0,0,1] neg_hi:[0,0,1]
    v_pk_mul_f32 v[28:29], v[150:151], v[146:147] op_sel:[0,1] op_sel_hi:[1,1]
    v_pk_fma_f32 v[82:83], v[82:83], v[146:147], v[28:29] op_sel_hi:[1,0,1] neg_lo:[0,0,1] neg_hi:[0,0,1]
    v_pk_mul_f32 v[28:29], v[152:153], v[146:147] op_sel:[0,1] op_sel_hi:[1,1]
    v_pk_fma_f32 v[84:85], v[84:85], v[146:147], v[28:29] op_sel_hi:[1,0,1] neg_lo:[0,0,1] neg_hi:[0,0,1]
    v_pk_mul_f32 v[28:29], v[154:155], v[146:147] op_sel:[0,1] op_sel_hi:[1,1]
    v_pk_fma_f32 v[86:87], v[86:87], v[146:147], v[28:29] op_sel_hi:[1,0,1] neg_lo:[0,0,1] neg_hi:[0,0,1]
    v_pk_mul_f32 v[28:29], v[156:157], v[146:147] op_sel:[0,1] op_sel_hi:[1,1]
    v_pk_fma_f32 v[88:89], v[88:89], v[146:147], v[28:29] op_sel_hi:[1,0,1] neg_lo:[0,0,1] neg_hi:[0,0,1]
    v_pk_mul_f32 v[28:29], v[158:159], v[146:147] op_sel:[0,1] op_sel_hi:[1,1]
    v_pk_fma_f32 v[90:91], v[90:91], v[146:147], v[28:29] op_sel_hi:[1,0,1] neg_lo:[0,0,1] neg_hi:[0,0,1]
    v_pk_mul_f32 v[28:29], v[160:161], v[146:147] op_sel:[0,1] op_sel_hi:[1,1]
    v_pk_fma_f32 v[92:93], v[92:93], v[146:147], v[28:29] op_sel_hi:[1,0,1] neg_lo:[0,0,1] neg_hi:[0,0,1]
    v_pk_mul_f32 v[28:29], v[162:163], v[146:147] op_sel:[0,1] op_sel_hi:[1,1]
    v_pk_fma_f32 v[94:95], v[94:95], v[146:147], v[28:29] op_sel_hi:[1,0,1] neg_lo:[0,0,1] neg_hi:[0,0,1]
    v_cvt_pk_bf16_f32 v12, v80, v81
    v_cvt_pk_bf16_f32 v13, v82, v83
    v_cvt_pk_bf16_f32 v14, v84, v85
    v_cvt_pk_bf16_f32 v15, v86, v87
    v_cvt_pk_bf16_f32 v16, v88, v89
    v_cvt_pk_bf16_f32 v17, v90, v91
    v_cvt_pk_bf16_f32 v18, v92, v93
    v_cvt_pk_bf16_f32 v19, v94, v95
    buffer_store_dwordx4 v[12:15], v2, s[16:19], s40 offen offset:0 sc1
    buffer_store_dwordx4 v[16:19], v2, s[16:19], s40 offen offset:1024 sc1
    s_waitcnt lgkmcnt(0)
    ds_read_b128 v[64:67], v7 offset:128
    ds_read_b128 v[80:83], v7 offset:640
    ds_read_b128 v[68:71], v7 offset:160
    ds_read_b128 v[84:87], v7 offset:672
    ds_read_b128 v[72:75], v7 offset:192
    ds_read_b128 v[88:91], v7 offset:704
    ds_read_b128 v[76:79], v7 offset:224
    ds_read_b128 v[92:95], v7 offset:736
    v_pk_mul_f32 v[28:29], v[48:49], v[4:5] op_sel:[0,1] op_sel_hi:[1,1]
    v_pk_fma_f32 v[96:97], v[96:97], v[32:33], v[28:29] neg_lo:[0,0,1] neg_hi:[0,0,1]
    v_pk_mul_f32 v[28:29], v[50:51], v[4:5] op_sel:[0,1] op_sel_hi:[1,1]
    v_pk_fma_f32 v[98:99], v[98:99], v[34:35], v[28:29] neg_lo:[0,0,1] neg_hi:[0,0,1]
    v_pk_mul_f32 v[28:29], v[52:53], v[4:5] op_sel:[0,1] op_sel_hi:[1,1]
    v_pk_fma_f32 v[100:101], v[100:101], v[36:37], v[28:29] neg_lo:[0,0,1] neg_hi:[0,0,1]
    v_pk_mul_f32 v[28:29], v[54:55], v[4:5] op_sel:[0,1] op_sel_hi:[1,1]
    v_pk_fma_f32 v[102:103], v[102:103], v[38:39], v[28:29] neg_lo:[0,0,1] neg_hi:[0,0,1]
    v_pk_mul_f32 v[28:29], v[56:57], v[4:5] op_sel:[0,1] op_sel_hi:[1,1]
    v_pk_fma_f32 v[104:105], v[104:105], v[40:41], v[28:29] neg_lo:[0,0,1] neg_hi:[0,0,1]
    v_pk_mul_f32 v[28:29], v[58:59], v[4:5] op_sel:[0,1] op_sel_hi:[1,1]
    v_pk_fma_f32 v[106:107], v[106:107], v[42:43], v[28:29] neg_lo:[0,0,1] neg_hi:[0,0,1]
    v_pk_mul_f32 v[28:29], v[60:61], v[4:5] op_sel:[0,1] op_sel_hi:[1,1]
    v_pk_fma_f32 v[108:109], v[108:109], v[44:45], v[28:29] neg_lo:[0,0,1] neg_hi:[0,0,1]
    v_pk_mul_f32 v[28:29], v[62:63], v[4:5] op_sel:[0,1] op_sel_hi:[1,1]
    v_pk_fma_f32 v[110:111], v[110:111], v[46:47], v[28:29] neg_lo:[0,0,1] neg_hi:[0,0,1]
    v_cvt_pk_bf16_f32 v20, v96, v97
    v_cvt_pk_bf16_f32 v21, v98, v99
    v_cvt_pk_bf16_f32 v22, v100, v101
    v_cvt_pk_bf16_f32 v23, v102, v103
    v_cvt_pk_bf16_f32 v24, v104, v105
    v_cvt_pk_bf16_f32 v25, v106, v107
    v_cvt_pk_bf16_f32 v26, v108, v109
    v_cvt_pk_bf16_f32 v27, v110, v111
    buffer_store_dwordx4 v[20:23], v30, s[16:19], s39 offen offset:0 sc1
    buffer_store_dwordx4 v[24:27], v30, s[16:19], s39 offen offset:1024 sc1
    s_waitcnt lgkmcnt(0)
    v_pk_mul_f32 v[28:29], v[80:81], v[4:5] op_sel:[0,1] op_sel_hi:[1,1]
    v_pk_fma_f32 v[112:113], v[112:113], v[64:65], v[28:29] neg_lo:[0,0,1] neg_hi:[0,0,1]
    v_pk_mul_f32 v[28:29], v[82:83], v[4:5] op_sel:[0,1] op_sel_hi:[1,1]
    v_pk_fma_f32 v[114:115], v[114:115], v[66:67], v[28:29] neg_lo:[0,0,1] neg_hi:[0,0,1]
    v_pk_mul_f32 v[28:29], v[84:85], v[4:5] op_sel:[0,1] op_sel_hi:[1,1]
    v_pk_fma_f32 v[116:117], v[116:117], v[68:69], v[28:29] neg_lo:[0,0,1] neg_hi:[0,0,1]
    v_pk_mul_f32 v[28:29], v[86:87], v[4:5] op_sel:[0,1] op_sel_hi:[1,1]
    v_pk_fma_f32 v[118:119], v[118:119], v[70:71], v[28:29] neg_lo:[0,0,1] neg_hi:[0,0,1]
    v_pk_mul_f32 v[28:29], v[88:89], v[4:5] op_sel:[0,1] op_sel_hi:[1,1]
    v_pk_fma_f32 v[120:121], v[120:121], v[72:73], v[28:29] neg_lo:[0,0,1] neg_hi:[0,0,1]
    v_pk_mul_f32 v[28:29], v[90:91], v[4:5] op_sel:[0,1] op_sel_hi:[1,1]
    v_pk_fma_f32 v[122:123], v[122:123], v[74:75], v[28:29] neg_lo:[0,0,1] neg_hi:[0,0,1]
    v_pk_mul_f32 v[28:29], v[92:93], v[4:5] op_sel:[0,1] op_sel_hi:[1,1]
    v_pk_fma_f32 v[124:125], v[124:125], v[76:77], v[28:29] neg_lo:[0,0,1] neg_hi:[0,0,1]
    v_pk_mul_f32 v[28:29], v[94:95], v[4:5] op_sel:[0,1] op_sel_hi:[1,1]
    v_pk_fma_f32 v[126:127], v[126:127], v[78:79], v[28:29] neg_lo:[0,0,1] neg_hi:[0,0,1]
    v_cvt_pk_bf16_f32 v12, v112, v113
    v_cvt_pk_bf16_f32 v13, v114, v115
    v_cvt_pk_bf16_f32 v14, v116, v117
    v_cvt_pk_bf16_f32 v15, v118, v119
    v_cvt_pk_bf16_f32 v16, v120, v121
    v_cvt_pk_bf16_f32 v17, v122, v123
    v_cvt_pk_bf16_f32 v18, v124, v125
    v_cvt_pk_bf16_f32 v19, v126, v127
    buffer_store_dwordx4 v[12:15], v30, s[16:19], s41 offen offset:0 sc1
    buffer_store_dwordx4 v[16:19], v30, s[16:19], s41 offen offset:1024 sc1
    v_mov_b32 v2, 1
    s_waitcnt vmcnt(0)
    s_mov_b64 exec, 7
    buffer_store_dword v2, v31, s[24:27], 0 offen sc1
    s_mov_b64 exec, -1
    v_mov_b32 v3, 64520
    s_mov_b64 exec, 1
    ds_add_u32 v3, v2
    s_mov_b64 exec, -1
    s_branch L_att
L_stats:
    s_sub_u32 s50, s22, 6
    s_lshl_b32 s50, s50, 1
    s_lshl_b32 s35, s33, 3
    s_add_u32 s50, s50, s35
    s_lshl_b32 s35, s32, 7
    s_add_u32 s50, s50, s35
    s_lshl_b32 s51, s50, 11
    v_lshlrev_b32 v2, 4, v1
    s_waitcnt lgkmcnt(0)
    s_mov_b32 s8, s4
    s_mov_b32 s9, s5
    s_mov_b32 s10, 4194304
    s_mov_b32 s11, 0x20000
    s_add_u32 s24, s46, 20971520
    s_addc_u32 s25, s47, 0
    s_mov_b32 s26, 1048576
    s_mov_b32 s27, 0x20000
    s_mov_b32 s36, s42
    s_mov_b32 s37, s43
    s_mov_b32 s38, 2048
    s_mov_b32 s39, 0x20000
    s_sub_u32 s62, s22, 7
    s_or_b32 s62, s62, s2
    s_barrier
    s_barrier
    s_barrier
    s_barrier
    buffer_load_dwordx4 v[64:67], v2, s[8:11], s51 offen offset:0
    buffer_load_dwordx4 v[68:71], v2, s[8:11], s51 offen offset:1024
    buffer_load_dwordx4 v[72:75], v2, s[8:11], s51 offen offset:2048
    buffer_load_dwordx4 v[76:79], v2, s[8:11], s51 offen offset:3072
    buffer_load_dwordx4 v[4:7], v2, s[36:39], 0 offen
    buffer_load_dwordx4 v[8:11], v2, s[36:39], 0 offen offset:1024
    s_barrier
    s_barrier
    s_waitcnt vmcnt(0)
    v_lshlrev_b32 v80, 16, v4
    v_and_b32 v81, 0xffff0000, v4
    v_lshlrev_b32 v82, 16, v5
    v_and_b32 v83, 0xffff0000, v5
    v_lshlrev_b32 v84, 16, v6
    v_and_b32 v85, 0xffff0000, v6
    v_lshlrev_b32 v86, 16, v7
    v_and_b32 v87, 0xffff0000, v7
    v_lshlrev_b32 v88, 16, v8
    v_and_b32 v89, 0xffff0000, v8
    v_lshlrev_b32 v90, 16, v9
    v_and_b32 v91, 0xffff0000, v9
    v_lshlrev_b32 v92, 16, v10
    v_and_b32 v93, 0xffff0000, v10
    v_lshlrev_b32 v94, 16, v11
    v_and_b32 v95, 0xffff0000, v11
    v_add_f32 v38, v80, v81
    v_add_f32 v38, v38, v82
    v_add_f32 v38, v38, v83
    v_add_f32 v38, v38, v84
    v_add_f32 v38, v38, v85
    v_add_f32 v38, v38, v86
    v_add_f32 v38, v38, v87
    v_add_f32 v38, v38, v88
    v_add_f32 v38, v38, v89
    v_add_f32 v38, v38, v90
    v_add_f32 v38, v38, v91
    v_add_f32 v38, v38, v92
    v_add_f32 v38, v38, v93
    v_add_f32 v38, v38, v94
    v_add_f32 v38, v38, v95
    v_lshlrev_b32 v24, 16, v64
    v_and_b32 v25, 0xffff0000, v64
    v_add_f32 v32, v24, v25
    v_mul_f32 v34, v24, v24
    v_mul_f32 v36, v24, v80
    v_fmac_f32 v34, v25, v25
    v_fmac_f32 v36, v25, v81
    v_lshlrev_b32 v26, 16, v65
    v_and_b32 v27, 0xffff0000, v65
    v_add_f32 v32, v32, v26
    v_fmac_f32 v34, v26, v26
    v_fmac_f32 v36, v26, v82
    v_add_f32 v32, v32, v27
    v_fmac_f32 v34, v27, v27
    v_fmac_f32 v36, v27, v83
    v_lshlrev_b32 v24, 16, v66
    v_and_b32 v25, 0xffff0000, v66
    v_add_f32 v32, v32, v24
    v_fmac_f32 v34, v24, v24
    v_fmac_f32 v36, v24, v84
    v_add_f32 v32, v32, v25
    v_fmac_f32 v34, v25, v25
    v_fmac_f32 v36, v25, v85
    v_lshlrev_b32 v26, 16, v67
    v_and_b32 v27, 0xffff0000, v67
    v_add_f32 v32, v32, v26
    v_fmac_f32 v34, v26, v26
    v_fmac_f32 v36, v26, v86
    v_add_f32 v32, v32, v27
    v_fmac_f32 v34, v27, v27
    v_fmac_f32 v36, v27, v87
    v_lshlrev_b32 v24, 16, v68
    v_and_b32 v25, 0xffff0000, v68
    v_add_f32 v32, v32, v24
    v_fmac_f32 v34, v24, v24
    v_fmac_f32 v36, v24, v88
    v_add_f32 v32, v32, v25
    v_fmac_f32 v34, v25, v25
    v_fmac_f32 v36, v25, v89
    v_lshlrev_b32 v26, 16, v69
    v_and_b32 v27, 0xffff0000, v69
    v_add_f32 v32, v32, v26
    v_fmac_f32 v34, v26, v26
    v_fmac_f32 v36, v26, v90
    v_add_f32 v32, v32, v27
    v_fmac_f32 v34, v27, v27
    s_barrier
    v_fmac_f32 v36, v27, v91
    v_lshlrev_b32 v24, 16, v70
    v_and_b32 v25, 0xffff0000, v70
    v_add_f32 v32, v32, v24
    v_fmac_f32 v34, v24, v24
    v_fmac_f32 v36, v24, v92
    v_add_f32 v32, v32, v25
    v_fmac_f32 v34, v25, v25
    v_fmac_f32 v36, v25, v93
    v_lshlrev_b32 v26, 16, v71
    v_and_b32 v27, 0xffff0000, v71
    v_add_f32 v32, v32, v26
    v_fmac_f32 v34, v26, v26
    v_fmac_f32 v36, v26, v94
    v_add_f32 v32, v32, v27
    v_fmac_f32 v34, v27, v27
    v_fmac_f32 v36, v27, v95
    v_lshlrev_b32 v24, 16, v72
    v_and_b32 v25, 0xffff0000, v72
    v_add_f32 v33, v24, v25
    v_mul_f32 v35, v24, v24
    v_mul_f32 v37, v24, v80
    v_fmac_f32 v35, v25, v25
    v_fmac_f32 v37, v25, v81
    v_lshlrev_b32 v26, 16, v73
    v_and_b32 v27, 0xffff0000, v73
    v_add_f32 v33, v33, v26
    v_fmac_f32 v35, v26, v26
    v_fmac_f32 v37, v26, v82
    v_add_f32 v33, v33, v27
    v_fmac_f32 v35, v27, v27
    v_fmac_f32 v37, v27, v83
    v_lshlrev_b32 v24, 16, v74
    v_and_b32 v25, 0xffff0000, v74
    v_add_f32 v33, v33, v24
    v_fmac_f32 v35, v24, v24
    v_fmac_f32 v37, v24, v84
    v_add_f32 v33, v33, v25
    v_fmac_f32 v35, v25, v25
    v_fmac_f32 v37, v25, v85
    v_lshlrev_b32 v26, 16, v75
    v_and_b32 v27, 0xffff0000, v75
    v_add_f32 v33, v33, v26
    v_fmac_f32 v35, v26, v26
    v_fmac_f32 v37, v26, v86
    v_add_f32 v33, v33, v27
    v_fmac_f32 v35, v27, v27
    v_fmac_f32 v37, v27, v87
    v_lshlrev_b32 v24, 16, v76
    v_and_b32 v25, 0xffff0000, v76
    v_add_f32 v33, v33, v24
    v_fmac_f32 v35, v24, v24
    v_fmac_f32 v37, v24, v88
    v_add_f32 v33, v33, v25
    v_fmac_f32 v35, v25, v25
    v_fmac_f32 v37, v25, v89
    v_lshlrev_b32 v26, 16, v77
    v_and_b32 v27, 0xffff0000, v77
    v_add_f32 v33, v33, v26
    v_fmac_f32 v35, v26, v26
    v_fmac_f32 v37, v26, v90
    v_add_f32 v33, v33, v27
    v_fmac_f32 v35, v27, v27
    v_fmac_f32 v37, v27, v91
    v_lshlrev_b32 v24, 16, v78
    v_and_b32 v25, 0xffff0000, v78
    v_add_f32 v33, v33, v24
    v_fmac_f32 v35, v24, v24
    v_fmac_f32 v37, v24, v92
    v_add_f32 v33, v33, v25
    v_fmac_f32 v35, v25, v25
    v_fmac_f32 v37, v25, v93
    v_lshlrev_b32 v26, 16, v79
    v_and_b32 v27, 0xffff0000, v79
    v_add_f32 v33, v33, v26
    v_fmac_f32 v35, v26, v26
    v_fmac_f32 v37, v26, v94
    v_add_f32 v33, v33, v27
    s_barrier
    v_fmac_f32 v35, v27, v27
    v_fmac_f32 v37, v27, v95
    v_mov_b32 v39, v38
    s_nop 1
    v_permlane32_swap_b32 v32, v33
    v_permlane32_swap_b32 v34, v35
    v_permlane32_swap_b32 v36, v37
    v_permlane32_swap_b32 v38, v39
    s_nop 1
    v_add_f32 v32, v32, v33
    v_add_f32 v34, v34, v35
    v_add_f32 v36, v36, v37
    v_add_f32 v38, v38, v39
    v_mov_b32 v33, v32
    v_mov_b32 v35, v34
    v_mov_b32 v37, v36
    v_mov_b32 v39, v38
    s_nop 1
    v_permlane16_swap_b32 v32, v33
    v_permlane16_swap_b32 v34, v35
    v_permlane16_swap_b32 v36, v37
    v_permlane16_swap_b32 v38, v39
    s_nop 1
    v_add_f32 v32, v32, v33
    v_add_f32 v34, v34, v35
    v_add_f32 v36, v36, v37
    v_add_f32 v38, v38, v39
    s_nop 0
    v_add_f32_dpp v32, v32, v32 quad_perm:[1,0,3,2] row_mask:0xf bank_mask:0xf
    v_add_f32_dpp v34, v34, v34 quad_perm:[1,0,3,2] row_mask:0xf bank_mask:0xf
    v_add_f32_dpp v36, v36, v36 quad_perm:[1,0,3,2] row_mask:0xf bank_mask:0xf
    v_add_f32_dpp v38, v38, v38 quad_perm:[1,0,3,2] row_mask:0xf bank_mask:0xf
    s_nop 0
    v_add_f32_dpp v32, v32, v32 quad_perm:[2,3,0,1] row_mask:0xf bank_mask:0xf
    v_add_f32_dpp v34, v34, v34 quad_perm:[2,3,0,1] row_mask:0xf bank_mask:0xf
    v_add_f32_dpp v36, v36, v36 quad_perm:[2,3,0,1] row_mask:0xf bank_mask:0xf
    v_add_f32_dpp v38, v38, v38 quad_perm:[2,3,0,1] row_mask:0xf bank_mask:0xf
    s_nop 0
    v_add_f32_dpp v32, v32, v32 row_half_mirror row_mask:0xf bank_mask:0xf
    v_add_f32_dpp v34, v34, v34 row_half_mirror row_mask:0xf bank_mask:0xf
    v_add_f32_dpp v36, v36, v36 row_half_mirror row_mask:0xf bank_mask:0xf
    v_add_f32_dpp v38, v38, v38 row_half_mirror row_mask:0xf bank_mask:0xf
    s_nop 0
    v_add_f32_dpp v32, v32, v32 row_mirror row_mask:0xf bank_mask:0xf
    v_add_f32_dpp v34, v34, v34 row_mirror row_mask:0xf bank_mask:0xf
    v_add_f32_dpp v36, v36, v36 row_mirror row_mask:0xf bank_mask:0xf
    v_add_f32_dpp v38, v38, v38 row_mirror row_mask:0xf bank_mask:0xf
    v_mul_f32 v32, 0x3a800000, v32
    v_mul_f32 v34, 0x3a800000, v34
    v_fma_f32 v34, -v32, v32, v34
    v_max_f32 v34, 0, v34
    v_cvt_pk_bf16_f32 v34, v34, v34
    v_and_b32 v34, 0xffff0000, v34
    v_add_f32 v34, 0x3727c5ac, v34
    v_cvt_pk_bf16_f32 v34, v34, v34
    v_and_b32 v34, 0xffff0000, v34
    v_sqrt_f32 v34, v34
    s_nop 0
    v_cvt_pk_bf16_f32 v34, v34, v34
    v_and_b32 v34, 0xffff0000, v34
    v_cvt_pk_bf16_f32 v32, v32, v32
    v_and_b32 v32, 0xffff0000, v32
    v_rcp_f32 v33, v34
    v_fma_f32 v36, -v32, v38, v36
    v_mul_f32 v36, v36, v33
    v_cvt_pk_bf16_f32 v36, v36, v36
    v_and_b32 v36, 0xffff0000, v36
    v_ashrrev_i32 v35, 31, v36
    v_or_b32 v35, 0x80000000, v35
    v_xor_b32 v36, v36, v35
    v_and_b32 v36, 0xffff0000, v36
    v_lshrrev_b32 v35, 5, v1
    v_add_u32 v35, s50, v35
    v_sub_u32 v37, 0xffff, v35
    v_or_b32 v36, v36, v37
    v_or_b32 v32, 1, v32
    v_or_b32 v33, 1, v33
    v_lshlrev_b32 v37, 2, v35
    v_lshlrev_b32 v35, 3, v35
    s_mov_b32 s35, 270336
    s_mov_b32 s51, 286720
    s_mov_b32 exec_lo, 1
    s_mov_b32 exec_hi, 1
    buffer_store_dwordx2 v[32:33], v35, s[24:27], s35 offen sc1
    buffer_store_dword v36, v37, s[24:27], s51 offen sc1
    s_mov_b64 exec, -1
    s_barrier
    s_barrier
    s_barrier
    s_cmp_eq_u32 s62, 0
    s_cbranch_scc0 L_g_3
    v_lshlrev_b32 v2, 4, v1
    s_mov_b32 s35, 286720
    s_mov_b32 s51, 290816
    buffer_load_dwordx4 v[32:35], v2, s[24:27], s35 offen offset:0 sc1
    buffer_load_dwordx4 v[36:39], v2, s[24:27], s35 offen offset:1024 sc1
    buffer_load_dwordx4 v[40:43], v2, s[24:27], s35 offen offset:2048 sc1
    buffer_load_dwordx4 v[44:47], v2, s[24:27], s35 offen offset:3072 sc1
    buffer_load_dwordx4 v[48:51], v2, s[24:27], s51 offen offset:0 sc1
    buffer_load_dwordx4 v[52:55], v2, s[24:27], s51 offen offset:1024 sc1
    buffer_load_dwordx4 v[56:59], v2, s[24:27], s51 offen offset:2048 sc1
    buffer_load_dwordx4 v[60:63], v2, s[24:27], s51 offen offset:3072 sc1
L_g_3:
    s_barrier
    s_barrier
    s_cmp_eq_u32 s62, 0
    s_cbranch_scc0 L_g_4
    s_mov_b32 s61, 262144
L_rt_1:
    s_waitcnt vmcnt(0)
    v_min3_u32 v25, v32, v33, v34
    v_min3_u32 v25, v25, v35, v36
    v_min3_u32 v25, v25, v37, v38
    v_min3_u32 v25, v25, v39, v40
    v_min3_u32 v25, v25, v41, v42
    v_min3_u32 v25, v25, v43, v44
    v_min3_u32 v25, v25, v45, v46
    v_min3_u32 v25, v25, v47, v48
    v_min3_u32 v25, v25, v49, v50
    v_min3_u32 v25, v25, v51, v52
    v_min3_u32 v25, v25, v53, v54
    v_min3_u32 v25, v25, v55, v56
    v_min3_u32 v25, v25, v57, v58
    v_min3_u32 v25, v25, v59, v60
    v_min3_u32 v25, v25, v61, v62
    v_min_u32 v25, v25, v63
    v_cmp_eq_u32 vcc, 0, v25
    s_nop 1
    s_cmp_eq_u64 vcc, 0
    s_cbranch_scc1 L_rte_2
    s_sleep 8
    buffer_load_dwordx4 v[32:35], v2, s[24:27], s35 offen offset:0 sc1
    buffer_load_dwordx4 v[36:39], v2, s[24:27], s35 offen offset:1024 sc1
    buffer_load_dwordx4 v[40:43], v2, s[24:27], s35 offen offset:2048 sc1
    buffer_load_dwordx4 v[44:47], v2, s[24:27], s35 offen offset:3072 sc1
    buffer_load_dwordx4 v[48:51], v2, s[24:27], s51 offen offset:0 sc1
    buffer_load_dwordx4 v[52:55], v2, s[24:27], s51 offen offset:1024 sc1
    buffer_load_dwordx4 v[56:59], v2, s[24:27], s51 offen offset:2048 sc1
    buffer_load_dwordx4 v[60:63], v2, s[24:27], s51 offen offset:3072 sc1
    s_sub_u32 s61, s61, 1
    s_cmp_lg_u32 s61, 0
    s_cbranch_scc1 L_rt_1
    s_waitcnt vmcnt(0)
L_rte_2:
    v_mov_b32 v24, -1
    v_mov_b32 v27, 0
    v_sub_u32 v64, v24, v32
    v_sub_u32 v65, v24, v33
    v_sub_u32 v66, v24, v34
    v_sub_u32 v67, v24, v35
    v_sub_u32 v68, v24, v36
    v_sub_u32 v69, v24, v37
    v_sub_u32 v70, v24, v38
    v_sub_u32 v71, v24, v39
    v_sub_u32 v72, v24, v40
    v_sub_u32 v73, v24, v41
    v_sub_u32 v74, v24, v42
    v_sub_u32 v75, v24, v43
    v_sub_u32 v76, v24, v44
    v_sub_u32 v77, v24, v45
    v_sub_u32 v78, v24, v46
    v_sub_u32 v79, v24, v47
    v_sub_u32 v80, v24, v48
    v_sub_u32 v81, v24, v49
    v_sub_u32 v82, v24, v50
    v_sub_u32 v83, v24, v51
    v_sub_u32 v84, v24, v52
    v_sub_u32 v85, v24, v53
    v_sub_u32 v86, v24, v54
    v_sub_u32 v87, v24, v55
    v_sub_u32 v88, v24, v56
    v_sub_u32 v89, v24, v57
    v_sub_u32 v90, v24, v58
    v_sub_u32 v91, v24, v59
    v_sub_u32 v92, v24, v60
    v_sub_u32 v93, v24, v61
    v_sub_u32 v94, v24, v62
    v_sub_u32 v95, v24, v63
    v_min3_u32 v25, v64, v65, v66
    v_min3_u32 v25, v25, v67, v68
    v_min3_u32 v25, v25, v69, v70
    v_min3_u32 v25, v25, v71, v72
    v_min3_u32 v25, v25, v73, v74
    v_min3_u32 v25, v25, v75, v76
    v_min3_u32 v25, v25, v77, v78
    v_min3_u32 v25, v25, v79, v80
    v_min3_u32 v25, v25, v81, v82
    v_min3_u32 v25, v25, v83, v84
    v_min3_u32 v25, v25, v85, v86
    v_min3_u32 v25, v25, v87, v88
    v_min3_u32 v25, v25, v89, v90
    v_min3_u32 v25, v25, v91, v92
    v_min3_u32 v25, v25, v93, v94
    v_min_u32 v25, v25, v95
    s_nop 1
    v_min_u32_dpp v25, v25, v25 quad_perm:[1,0,3,2] row_mask:0xf bank_mask:0xf
    s_nop 1
    v_min_u32_dpp v25, v25, v25 quad_perm:[2,3,0,1] row_mask:0xf bank_mask:0xf
    s_nop 1
    v_min_u32_dpp v25, v25, v25 row_half_mirror row_mask:0xf bank_mask:0xf
    s_nop 1
    v_min_u32_dpp v25, v25, v25 row_mirror row_mask:0xf bank_mask:0xf
    s_nop 0
    v_mov_b32 v26, v25
    s_nop 1
    v_permlane16_swap_b32 v25, v26
    s_nop 1
    v_min_u32 v25, v25, v26
    s_nop 0
    v_mov_b32 v26, v25
    s_nop 1
    v_permlane32_swap_b32 v25, v26
    s_nop 1
    v_min_u32 v25, v25, v26
    v_sub_u32 v24, v24, v25
    v_cmp_eq_u32 vcc, 0, v1
    s_nop 1
    v_cndmask_b32 v27, v27, v24, vcc
    v_add_u32 v24, -1, v24
    v_sub_u32 v64, v24, v32
    v_sub_u32 v65, v24, v33
    v_sub_u32 v66, v24, v34
    v_sub_u32 v67, v24, v35
    v_sub_u32 v68, v24, v36
    v_sub_u32 v69, v24, v37
    v_sub_u32 v70, v24, v38
    v_sub_u32 v71, v24, v39
    v_sub_u32 v72, v24, v40
    v_sub_u32 v73, v24, v41
    v_sub_u32 v74, v24, v42
    v_sub_u32 v75, v24, v43
    v_sub_u32 v76, v24, v44
    v_sub_u32 v77, v24, v45
    v_sub_u32 v78, v24, v46
    v_sub_u32 v79, v24, v47
    v_sub_u32 v80, v24, v48
    v_sub_u32 v81, v24, v49
    v_sub_u32 v82, v24, v50
    v_sub_u32 v83, v24, v51
    v_sub_u32 v84, v24, v52
    v_sub_u32 v85, v24, v53
L_g_4:
    s_barrier
    s_cmp_eq_u32 s62, 0
    s_cbranch_scc0 L_g_5
    v_sub_u32 v86, v24, v54
    v_sub_u32 v87, v24, v55
    v_sub_u32 v88, v24, v56
    v_sub_u32 v89, v24, v57
    v_sub_u32 v90, v24, v58
    v_sub_u32 v91, v24, v59
    v_sub_u32 v92, v24, v60
    v_sub_u32 v93, v24, v61
    v_sub_u32 v94, v24, v62
    v_sub_u32 v95, v24, v63
    v_min3_u32 v25, v64, v65, v66
    v_min3_u32 v25, v25, v67, v68
    v_min3_u32 v25, v25, v69, v70
    v_min3_u32 v25, v25, v71, v72
    v_min3_u32 v25, v25, v73, v74
    v_min3_u32 v25, v25, v75, v76
    v_min3_u32 v25, v25, v77, v78
    v_min3_u32 v25, v25, v79, v80
    v_min3_u32 v25, v25, v81, v82
    v_min3_u32 v25, v25, v83, v84
    v_min3_u32 v25, v25, v85, v86
    v_min3_u32 v25, v25, v87, v88
    v_min3_u32 v25, v25, v89, v90
    v_min3_u32 v25, v25, v91, v92
    v_min3_u32 v25, v25, v93, v94
    v_min_u32 v25, v25, v95
    s_nop 1
    v_min_u32_dpp v25, v25, v25 quad_perm:[1,0,3,2] row_mask:0xf bank_mask:0xf
    s_nop 1
    v_min_u32_dpp v25, v25, v25 quad_perm:[2,3,0,1] row_mask:0xf bank_mask:0xf
    s_nop 1
    v_min_u32_dpp v25, v25, v25 row_half_mirror row_mask:0xf bank_mask:0xf
    s_nop 1
    v_min_u32_dpp v25, v25, v25 row_mirror row_mask:0xf bank_mask:0xf
    s_nop 0
    v_mov_b32 v26, v25
    s_nop 1
    v_permlane16_swap_b32 v25, v26
    s_nop 1
    v_min_u32 v25, v25, v26
    s_nop 0
    v_mov_b32 v26, v25
    s_nop 1
    v_permlane32_swap_b32 v25, v26
    s_nop 1
    v_min_u32 v25, v25, v26
    v_sub_u32 v24, v24, v25
    v_cmp_eq_u32 vcc, 1, v1
    s_nop 1
    v_cndmask_b32 v27, v27, v24, vcc
    v_add_u32 v24, -1, v24
    v_sub_u32 v64, v24, v32
    v_sub_u32 v65, v24, v33
    v_sub_u32 v66, v24, v34
    v_sub_u32 v67, v24, v35
    v_sub_u32 v68, v24, v36
    v_sub_u32 v69, v24, v37
    v_sub_u32 v70, v24, v38
    v_sub_u32 v71, v24, v39
    v_sub_u32 v72, v24, v40
    v_sub_u32 v73, v24, v41
    v_sub_u32 v74, v24, v42
    v_sub_u32 v75, v24, v43
    v_sub_u32 v76, v24, v44
    v_sub_u32 v77, v24, v45
    v_sub_u32 v78, v24, v46
    v_sub_u32 v79, v24, v47
    v_sub_u32 v80, v24, v48
    v_sub_u32 v81, v24, v49
    v_sub_u32 v82, v24, v50
    v_sub_u32 v83, v24, v51
    v_sub_u32 v84, v24, v52
    v_sub_u32 v85, v24, v53
    v_sub_u32 v86, v24, v54
    v_sub_u32 v87, v24, v55
    v_sub_u32 v88, v24, v56
    v_sub_u32 v89, v24, v57
    v_sub_u32 v90, v24, v58
    v_sub_u32 v91, v24, v59
    v_sub_u32 v92, v24, v60
    v_sub_u32 v93, v24, v61
    v_sub_u32 v94, v24, v62
    v_sub_u32 v95, v24, v63
    v_min3_u32 v25, v64, v65, v66
    v_min3_u32 v25, v25, v67, v68
    v_min3_u32 v25, v25, v69, v70
    v_min3_u32 v25, v25, v71, v72
    v_min3_u32 v25, v25, v73, v74
    v_min3_u32 v25, v25, v75, v76
    v_min3_u32 v25, v25, v77, v78
    v_min3_u32 v25, v25, v79, v80
    v_min3_u32 v25, v25, v81, v82
    v_min3_u32 v25, v25, v83, v84
    v_min3_u32 v25, v25, v85, v86
    v_min3_u32 v25, v25, v87, v88
    v_min3_u32 v25, v25, v89, v90
    v_min3_u32 v25, v25, v91, v92
    v_min3_u32 v25, v25, v93, v94
L_g_5:
    s_barrier
    s_cmp_eq_u32 s62, 0
    s_cbranch_scc0 L_g_6
    v_min_u32 v25, v25, v95
    s_nop 1
    v_min_u32_dpp v25, v25, v25 quad_perm:[1,0,3,2] row_mask:0xf bank_mask:0xf
    s_nop 1
    v_min_u32_dpp v25, v25, v25 quad_perm:[2,3,0,1] row_mask:0xf bank_mask:0xf
    s_nop 1
    v_min_u32_dpp v25, v25, v25 row_half_mirror row_mask:0xf bank_mask:0xf
    s_nop 1
    v_min_u32_dpp v25, v25, v25 row_mirror row_mask:0xf bank_mask:0xf
    s_nop 0
    v_mov_b32 v26, v25
    s_nop 1
    v_permlane16_swap_b32 v25, v26
    s_nop 1
    v_min_u32 v25, v25, v26
    s_nop 0
    v_mov_b32 v26, v25
    s_nop 1
    v_permlane32_swap_b32 v25, v26
    s_nop 1
    v_min_u32 v25, v25, v26
    v_sub_u32 v24, v24, v25
    v_cmp_eq_u32 vcc, 2, v1
    s_nop 1
    v_cndmask_b32 v27, v27, v24, vcc
    v_add_u32 v24, -1, v24
    v_sub_u32 v64, v24, v32
    v_sub_u32 v65, v24, v33
    v_sub_u32 v66, v24, v34
    v_sub_u32 v67, v24, v35
    v_sub_u32 v68, v24, v36
    v_sub_u32 v69, v24, v37
    v_sub_u32 v70, v24, v38
    v_sub_u32 v71, v24, v39
    v_sub_u32 v72, v24, v40
    v_sub_u32 v73, v24, v41
    v_sub_u32 v74, v24, v42
    v_sub_u32 v75, v24, v43
    v_sub_u32 v76, v24, v44
    v_sub_u32 v77, v24, v45
    v_sub_u32 v78, v24, v46
    v_sub_u32 v79, v24, v47
    v_sub_u32 v80, v24, v48
    v_sub_u32 v81, v24, v49
    v_sub_u32 v82, v24, v50
    v_sub_u32 v83, v24, v51
    v_sub_u32 v84, v24, v52
    v_sub_u32 v85, v24, v53
    v_sub_u32 v86, v24, v54
    v_sub_u32 v87, v24, v55
    v_sub_u32 v88, v24, v56
    v_sub_u32 v89, v24, v57
    v_sub_u32 v90, v24, v58
    v_sub_u32 v91, v24, v59
    v_sub_u32 v92, v24, v60
    v_sub_u32 v93, v24, v61
    v_sub_u32 v94, v24, v62
    v_sub_u32 v95, v24, v63
    v_min3_u32 v25, v64, v65, v66
    v_min3_u32 v25, v25, v67, v68
    v_min3_u32 v25, v25, v69, v70
    v_min3_u32 v25, v25, v71, v72
    v_min3_u32 v25, v25, v73, v74
    v_min3_u32 v25, v25, v75, v76
    v_min3_u32 v25, v25, v77, v78
    v_min3_u32 v25, v25, v79, v80
    v_min3_u32 v25, v25, v81, v82
    v_min3_u32 v25, v25, v83, v84
    v_min3_u32 v25, v25, v85, v86
    v_min3_u32 v25, v25, v87, v88
    v_min3_u32 v25, v25, v89, v90
    v_min3_u32 v25, v25, v91, v92
    v_min3_u32 v25, v25, v93, v94
    v_min_u32 v25, v25, v95
    s_nop 1
    v_min_u32_dpp v25, v25, v25 quad_perm:[1,0,3,2] row_mask:0xf bank_mask:0xf
    s_nop 1
    v_min_u32_dpp v25, v25, v25 quad_perm:[2,3,0,1] row_mask:0xf bank_mask:0xf
    s_nop 1
    v_min_u32_dpp v25, v25, v25 row_half_mirror row_mask:0xf bank_mask:0xf
    s_nop 1
    v_min_u32_dpp v25, v25, v25 row_mirror row_mask:0xf bank_mask:0xf
    s_nop 0
    v_mov_b32 v26, v25
    s_nop 1
    v_permlane16_swap_b32 v25, v26
    s_nop 1
    v_min_u32 v25, v25, v26
    s_nop 0
    v_mov_b32 v26, v25
    s_nop 1
    v_permlane32_swap_b32 v25, v26
    s_nop 1
    v_min_u32 v25, v25, v26
    v_sub_u32 v24, v24, v25
    v_cmp_eq_u32 vcc, 3, v1
    s_nop 1
    v_cndmask_b32 v27, v27, v24, vcc
L_g_6:
    s_barrier
    s_cmp_eq_u32 s62, 0
    s_cbranch_scc0 L_g_7
    v_add_u32 v24, -1, v24
    v_sub_u32 v64, v24, v32
    v_sub_u32 v65, v24, v33
    v_sub_u32 v66, v24, v34
    v_sub_u32 v67, v24, v35
    v_sub_u32 v68, v24, v36
    v_sub_u32 v69, v24, v37
    v_sub_u32 v70, v24, v38
    v_sub_u32 v71, v24, v39
    v_sub_u32 v72, v24, v40
    v_sub_u32 v73, v24, v41
    v_sub_u32 v74, v24, v42
    v_sub_u32 v75, v24, v43
    v_sub_u32 v76, v24, v44
    v_sub_u32 v77, v24, v45
    v_sub_u32 v78, v24, v46
    v_sub_u32 v79, v24, v47
    v_sub_u32 v80, v24, v48
    v_sub_u32 v81, v24, v49
    v_sub_u32 v82, v24, v50
    v_sub_u32 v83, v24, v51
    v_sub_u32 v84, v24, v52
    v_sub_u32 v85, v24, v53
    v_sub_u32 v86, v24, v54
    v_sub_u32 v87, v24, v55
    v_sub_u32 v88, v24, v56
    v_sub_u32 v89, v24, v57
    v_sub_u32 v90, v24, v58
    v_sub_u32 v91, v24, v59
    v_sub_u32 v92, v24, v60
    v_sub_u32 v93, v24, v61
    v_sub_u32 v94, v24, v62
    v_sub_u32 v95, v24, v63
    v_min3_u32 v25, v64, v65, v66
    v_min3_u32 v25, v25, v67, v68
    v_min3_u32 v25, v25, v69, v70
    v_min3_u32 v25, v25, v71, v72
    v_min3_u32 v25, v25, v73, v74
    v_min3_u32 v25, v25, v75, v76
    v_min3_u32 v25, v25, v77, v78
    v_min3_u32 v25, v25, v79, v80
    v_min3_u32 v25, v25, v81, v82
    v_min3_u32 v25, v25, v83, v84
    v_min3_u32 v25, v25, v85, v86
    v_min3_u32 v25, v25, v87, v88
    v_min3_u32 v25, v25, v89, v90
    v_min3_u32 v25, v25, v91, v92
    v_min3_u32 v25, v25, v93, v94
    v_min_u32 v25, v25, v95
    s_nop 1
    v_min_u32_dpp v25, v25, v25 quad_perm:[1,0,3,2] row_mask:0xf bank_mask:0xf
    s_nop 1
    v_min_u32_dpp v25, v25, v25 quad_perm:[2,3,0,1] row_mask:0xf bank_mask:0xf
    s_nop 1
    v_min_u32_dpp v25, v25, v25 row_half_mirror row_mask:0xf bank_mask:0xf
    s_nop 1
    v_min_u32_dpp v25, v25, v25 row_mirror row_mask:0xf bank_mask:0xf
    s_nop 0
    v_mov_b32 v26, v25
    s_nop 1
    v_permlane16_swap_b32 v25, v26
    s_nop 1
    v_min_u32 v25, v25, v26
    s_nop 0
    v_mov_b32 v26, v25
    s_nop 1
    v_permlane32_swap_b32 v25, v26
    s_nop 1
    v_min_u32 v25, v25, v26
    v_sub_u32 v24, v24, v25
    v_cmp_eq_u32 vcc, 4, v1
    s_nop 1
    v_cndmask_b32 v27, v27, v24, vcc
    v_add_u32 v24, -1, v24
    v_sub_u32 v64, v24, v32
    v_sub_u32 v65, v24, v33
    v_sub_u32 v66, v24, v34
    v_sub_u32 v67, v24, v35
    v_sub_u32 v68, v24, v36
    v_sub_u32 v69, v24, v37
    v_sub_u32 v70, v24, v38
    v_sub_u32 v71, v24, v39
    v_sub_u32 v72, v24, v40
    v_sub_u32 v73, v24, v41
    v_sub_u32 v74, v24, v42
    v_sub_u32 v75, v24, v43
    v_sub_u32 v76, v24, v44
    v_sub_u32 v77, v24, v45
    v_sub_u32 v78, v24, v46
    v_sub_u32 v79, v24, v47
    v_sub_u32 v80, v24, v48
    v_sub_u32 v81, v24, v49
    v_sub_u32 v82, v24, v50
    v_sub_u32 v83, v24, v51
    v_sub_u32 v84, v24, v52
    v_sub_u32 v85, v24, v53
    v_sub_u32 v86, v24, v54
    v_sub_u32 v87, v24, v55
    v_sub_u32 v88, v24, v56
    v_sub_u32 v89, v24, v57
    v_sub_u32 v90, v24, v58
    v_sub_u32 v91, v24, v59
    v_sub_u32 v92, v24, v60
    v_sub_u32 v93, v24, v61
    v_sub_u32 v94, v24, v62
    v_sub_u32 v95, v24, v63
    v_min3_u32 v25, v64, v65, v66
    v_min3_u32 v25, v25, v67, v68
    v_min3_u32 v25, v25, v69, v70
    v_min3_u32 v25, v25, v71, v72
    v_min3_u32 v25, v25, v73, v74
    v_min3_u32 v25, v25, v75, v76
    v_min3_u32 v25, v25, v77, v78
    v_min3_u32 v25, v25, v79, v80
    v_min3_u32 v25, v25, v81, v82
    v_min3_u32 v25, v25, v83, v84
    v_min3_u32 v25, v25, v85, v86
    v_min3_u32 v25, v25, v87, v88
    v_min3_u32 v25, v25, v89, v90
    v_min3_u32 v25, v25, v91, v92
    v_min3_u32 v25, v25, v93, v94
    v_min_u32 v25, v25, v95
    s_nop 1
    v_min_u32_dpp v25, v25, v25 quad_perm:[1,0,3,2] row_mask:0xf bank_mask:0xf
    s_nop 1
    v_min_u32_dpp v25, v25, v25 quad_perm:[2,3,0,1] row_mask:0xf bank_mask:0xf
    s_nop 1
    v_min_u32_dpp v25, v25, v25 row_half_mirror row_mask:0xf bank_mask:0xf
    s_nop 1
    v_min_u32_dpp v25, v25, v25 row_mirror row_mask:0xf bank_mask:0xf
    s_nop 0
    v_mov_b32 v26, v25
    s_nop 1
    v_permlane16_swap_b32 v25, v26
    s_nop 1
    v_min_u32 v25, v25, v26
    s_nop 0
    v_mov_b32 v26, v25
    s_nop 1
    v_permlane32_swap_b32 v25, v26
    s_nop 1
    v_min_u32 v25, v25, v26
    v_sub_u32 v24, v24, v25
    v_cmp_eq_u32 vcc, 5, v1
    s_nop 1
    v_cndmask_b32 v27, v27, v24, vcc
    v_add_u32 v24, -1, v24
    v_sub_u32 v64, v24, v32
    v_sub_u32 v65, v24, v33
    v_sub_u32 v66, v24, v34
    v_sub_u32 v67, v24, v35
    v_sub_u32 v68, v24, v36
    v_sub_u32 v69, v24, v37
    v_sub_u32 v70, v24, v38
    v_sub_u32 v71, v24, v39
    v_sub_u32 v72, v24, v40
    v_sub_u32 v73, v24, v41
    v_sub_u32 v74, v24, v42
    v_sub_u32 v75, v24, v43
    v_sub_u32 v76, v24, v44
    v_sub_u32 v77, v24, v45
    v_sub_u32 v78, v24, v46
    v_sub_u32 v79, v24, v47
    v_sub_u32 v80, v24, v48
    v_sub_u32 v81, v24, v49
    v_sub_u32 v82, v24, v50
    v_sub_u32 v83, v24, v51
    v_sub_u32 v84, v24, v52
    v_sub_u32 v85, v24, v53
    v_sub_u32 v86, v24, v54
    v_sub_u32 v87, v24, v55
    v_sub_u32 v88, v24, v56
    v_sub_u32 v89, v24, v57
    v_sub_u32 v90, v24, v58
    v_sub_u32 v91, v24, v59
    v_sub_u32 v92, v24, v60
    v_sub_u32 v93, v24, v61
    v_sub_u32 v94, v24, v62
    v_sub_u32 v95, v24, v63
    v_min3_u32 v25, v64, v65, v66
    v_min3_u32 v25, v25, v67, v68
    v_min3_u32 v25, v25, v69, v70
    v_min3_u32 v25, v25, v71, v72
    v_min3_u32 v25, v25, v73, v74
    v_min3_u32 v25, v25, v75, v76
    v_min3_u32 v25, v25, v77, v78
    v_min3_u32 v25, v25, v79, v80
    v_min3_u32 v25, v25, v81, v82
    v_min3_u32 v25, v25, v83, v84
    v_min3_u32 v25, v25, v85, v86
    v_min3_u32 v25, v25, v87, v88
    v_min3_u32 v25, v25, v89, v90
    v_min3_u32 v25, v25, v91, v92
    v_min3_u32 v25, v25, v93, v94
    v_min_u32 v25, v25, v95
    s_nop 1
    v_min_u32_dpp v25, v25, v25 quad_perm:[1,0,3,2] row_mask:0xf bank_mask:0xf
    s_nop 1
    v_min_u32_dpp v25, v25, v25 quad_perm:[2,3,0,1] row_mask:0xf bank_mask:0xf
    s_nop 1
    v_min_u32_dpp v25, v25, v25 row_half_mirror row_mask:0xf bank_mask:0xf
    s_nop 1
    v_min_u32_dpp v25, v25, v25 row_mirror row_mask:0xf bank_mask:0xf
    s_nop 0
    v_mov_b32 v26, v25
    s_nop 1
    v_permlane16_swap_b32 v25, v26
    s_nop 1
    v_min_u32 v25, v25, v26
    s_nop 0
    v_mov_b32 v26, v25
    s_nop 1
    v_permlane32_swap_b32 v25, v26
    s_nop 1
    v_min_u32 v25, v25, v26
    v_sub_u32 v24, v24, v25
    v_cmp_eq_u32 vcc, 6, v1
    s_nop 1
    v_cndmask_b32 v27, v27, v24, vcc
    v_add_u32 v24, -1, v24
    v_sub_u32 v64, v24, v32
    v_sub_u32 v65, v24, v33
    v_sub_u32 v66, v24, v34
    v_sub_u32 v67, v24, v35
    v_sub_u32 v68, v24, v36
    v_sub_u32 v69, v24, v37
    v_sub_u32 v70, v24, v38
    v_sub_u32 v71, v24, v39
    v_sub_u32 v72, v24, v40
    v_sub_u32 v73, v24, v41
    v_sub_u32 v74, v24, v42
    v_sub_u32 v75, v24, v43
    v_sub_u32 v76, v24, v44
    v_sub_u32 v77, v24, v45
    v_sub_u32 v78, v24, v46
    v_sub_u32 v79, v24, v47
    v_sub_u32 v80, v24, v48
    v_sub_u32 v81, v24, v49
    v_sub_u32 v82, v24, v50
    v_sub_u32 v83, v24, v51
    v_sub_u32 v84, v24, v52
    v_sub_u32 v85, v24, v53
    v_sub_u32 v86, v24, v54
    v_sub_u32 v87, v24, v55
    v_sub_u32 v88, v24, v56
    v_sub_u32 v89, v24, v57
    v_sub_u32 v90, v24, v58
    v_sub_u32 v91, v24, v59
    v_sub_u32 v92, v24, v60
    v_sub_u32 v93, v24, v61
    v_sub_u32 v94, v24, v62
    v_sub_u32 v95, v24, v63
    v_min3_u32 v25, v64, v65, v66
    v_min3_u32 v25, v25, v67, v68
    v_min3_u32 v25, v25, v69, v70
    v_min3_u32 v25, v25, v71, v72
    v_min3_u32 v25, v25, v73, v74
    v_min3_u32 v25, v25, v75, v76
    v_min3_u32 v25, v25, v77, v78
    v_min3_u32 v25, v25, v79, v80
    v_min3_u32 v25, v25, v81, v82
    v_min3_u32 v25, v25, v83, v84
    v_min3_u32 v25, v25, v85, v86
    v_min3_u32 v25, v25, v87, v88
    v_min3_u32 v25, v25, v89, v90
    v_min3_u32 v25, v25, v91, v92
    v_min3_u32 v25, v25, v93, v94
    v_min_u32 v25, v25, v95
    s_nop 1
    v_min_u32_dpp v25, v25, v25 quad_perm:[1,0,3,2] row_mask:0xf bank_mask:0xf
    s_nop 1
    v_min_u32_dpp v25, v25, v25 quad_perm:[2,3,0,1] row_mask:0xf bank_mask:0xf
    s_nop 1
    v_min_u32_dpp v25, v25, v25 row_half_mirror row_mask:0xf bank_mask:0xf
    s_nop 1
    v_min_u32_dpp v25, v25, v25 row_mirror row_mask:0xf bank_mask:0xf
    s_nop 0
    v_mov_b32 v26, v25
    s_nop 1
    v_permlane16_swap_b32 v25, v26
    s_nop 1
    v_min_u32 v25, v25, v26
    s_nop 0
    v_mov_b32 v26, v25
    s_nop 1
    v_permlane32_swap_b32 v25, v26
    s_nop 1
    v_min_u32 v25, v25, v26
    v_sub_u32 v24, v24, v25
    v_cmp_eq_u32 vcc, 7, v1
    s_nop 1
    v_cndmask_b32 v27, v27, v24, vcc
    v_add_u32 v24, -1, v24
    v_and_b32 v15, 0xffff, v27
    v_sub_u32 v15, 0x10000, v15
    v_and_b32 v16, 0xffff0000, v27
    v_ashrrev_i32 v17, 31, v16
    v_not_b32 v17, v17
    v_or_b32 v17, 0x80000000, v17
    v_xor_b32 v16, v16, v17
    v_and_b32 v16, 0xffff0000, v16
    v_mul_f32 v16, 0xbfb8aa3b, v16
    v_exp_f32 v16, v16
    s_nop 0
    v_add_f32 v16, 1.0, v16
    v_rcp_f32 v16, v16
    s_nop 0
    v_cvt_pk_bf16_f32 v16, v16, v16
    v_and_b32 v16, 0xffff0000, v16
    v_or_b32 v16, 1, v16
    v_lshlrev_b32 v3, 2, v1
    s_mov_b32 s35, 262144
    s_mov_b64 exec, 0xff
    buffer_store_dword v15, v3, s[24:27], s35 offen sc1
    buffer_store_dword v16, v3, s[24:27], s35 offen offset:32 sc1
    s_mov_b64 exec, -1
L_g_7:
    v_mov_b32 v143, 0x7ffffff0
    s_branch L_att
L_dma:
    s_sub_u32 s34, s22, 4
    s_lshl_b32 s34, s34, 1
    s_lshl_b32 s35, s34, 4
    v_lshrrev_b32 v18, 3, v1
    v_and_b32 v19, 7, v1
    v_add_u32 v21, s35, v18
    v_mul_u32_u24 v21, 6144, v21
    v_bfe_u32 v22, v1, 4, 1
    v_lshlrev_b32 v22, 2, v22
    v_xor_b32 v22, v19, v22
    v_lshl_add_u32 v21, v22, 4, v21
    s_add_u32 s35, s33, 0
    s_and_b32 s35, s35, 15
    s_lshl_b32 s35, s35, 7
    v_add_u32 v23, s35, v21
    v_add_u32 v6, 0, v23
    v_add_u32 v7, 48128, v23
    s_add_u32 s35, s33, 3
    s_and_b32 s35, s35, 15
    s_lshl_b32 s35, s35, 7
    v_add_u32 v23, s35, v21
    v_add_u32 v8, 0, v23
    v_add_u32 v9, 48128, v23
    s_add_u32 s35, s33, 6
    s_and_b32 s35, s35, 15
    s_lshl_b32 s35, s35, 7
    v_add_u32 v23, s35, v21
    v_add_u32 v10, 4096, v23
    v_add_u32 v11, 52224, v23
    v_lshrrev_b32 v20, 4, v1
    s_lshl_b32 s35, s32, 7
    s_lshl_b32 s40, s34, 5
    s_add_u32 s35, s35, s40
    v_add_u32 v21, s35, v18
    v_lshlrev_b32 v21, 11, v21
    v_xor_b32 v22, v19, v20
    v_xor_b32 v23, 4, v22
    v_lshl_add_u32 v2, v22, 4, v21
    v_lshl_add_u32 v3, v23, 4, v21
    v_add_u32 v4, 30720, v2
    v_add_u32 v5, 46080, v3
    v_add_u32 v3, 15360, v3
    s_mul_i32 s23, s34, 10240
    s_lshl_b32 s20, s48, 7
    s_mul_i32 s21, s48, 393216
    s_add_u32 s40, s20, 65536
    s_add_u32 s41, s21, 98304
    s_waitcnt lgkmcnt(0)
    s_mov_b32 s8, s4
    s_mov_b32 s9, s5
    s_mov_b32 s10, 4194304
    s_mov_b32 s11, 0x20000
    s_mov_b32 s12, s6
    s_mov_b32 s13, s7
    s_mov_b32 s14, 6291456
    s_mov_b32 s15, 0x20000
    s_add_u32 m0, s23, 4096
    s_nop 0
    buffer_load_dwordx4 v6, s[12:15], s21 offen offset:0 lds
    buffer_load_dwordx4 v7, s[12:15], s21 offen offset:1024 lds
    buffer_load_dwordx4 v8, s[12:15], s21 offen offset:2048 lds
    buffer_load_dwordx4 v9, s[12:15], s21 offen offset:3072 lds
    s_add_u32 m0, m0, 4096
    s_nop 0
    buffer_load_dwordx4 v10, s[12:15], s21 offen offset:0 lds
    buffer_load_dwordx4 v11, s[12:15], s21 offen offset:1024 lds
    s_add_u32 m0, s23, 0
    s_nop 0
    buffer_load_dwordx4 v2, s[8:11], s20 offen offset:0 lds
    buffer_load_dwordx4 v3, s[8:11], s20 offen offset:1024 lds
    buffer_load_dwordx4 v4, s[8:11], s20 offen offset:2048 lds
    buffer_load_dwordx4 v5, s[8:11], s20 offen offset:3072 lds
    s_add_u32 m0, s23, 14336
    s_nop 0
    buffer_load_dwordx4 v6, s[12:15], s41 offen offset:0 lds
    buffer_load_dwordx4 v7, s[12:15], s41 offen offset:1024 lds
    buffer_load_dwordx4 v8, s[12:15], s41 offen offset:2048 lds
    buffer_load_dwordx4 v9, s[12:15], s41 offen offset:3072 lds
    s_add_u32 m0, m0, 4096
    s_nop 0
    buffer_load_dwordx4 v10, s[12:15], s41 offen offset:0 lds
    buffer_load_dwordx4 v11, s[12:15], s41 offen offset:1024 lds
    s_add_u32 m0, s23, 10240
    s_nop 0
    buffer_load_dwordx4 v2, s[8:11], s40 offen offset:0 lds
    buffer_load_dwordx4 v3, s[8:11], s40 offen offset:1024 lds
    buffer_load_dwordx4 v4, s[8:11], s40 offen offset:2048 lds
    buffer_load_dwordx4 v5, s[8:11], s40 offen offset:3072 lds
    s_add_u32 s20, s20, 128
    s_and_b32 s20, s20, 2047
    s_add_u32 s40, s20, 65536
    s_mul_i32 s21, s20, 3072
    s_add_u32 s41, s21, 98304
    s_add_u32 s23, s23, 40960
    s_cmp_ge_u32 s23, 122880
    s_cselect_b32 s35, 122880, 0
    s_sub_u32 s23, s23, s35
    s_add_u32 m0, s23, 4096
    s_nop 0
    buffer_load_dwordx4 v6, s[12:15], s21 offen offset:0 lds
    buffer_load_dwordx4 v7, s[12:15], s21 offen offset:1024 lds
    buffer_load_dwordx4 v8, s[12:15], s21 offen offset:2048 lds
    buffer_load_dwordx4 v9, s[12:15], s21 offen offset:3072 lds
    s_add_u32 m0, m0, 4096
    s_nop 0
    buffer_load_dwordx4 v10, s[12:15], s21 offen offset:0 lds
    buffer_load_dwordx4 v11, s[12:15], s21 offen offset:1024 lds
    s_add_u32 m0, s23, 0
    s_nop 0
    buffer_load_dwordx4 v2, s[8:11], s20 offen offset:0 lds
    buffer_load_dwordx4 v3, s[8:11], s20 offen offset:1024 lds
    buffer_load_dwordx4 v4, s[8:11], s20 offen offset:2048 lds
    buffer_load_dwordx4 v5, s[8:11], s20 offen offset:3072 lds
    s_add_u32 m0, s23, 14336
    s_nop 0
    buffer_load_dwordx4 v6, s[12:15], s41 offen offset:0 lds
    buffer_load_dwordx4 v7, s[12:15], s41 offen offset:1024 lds
    buffer_load_dwordx4 v8, s[12:15], s41 offen offset:2048 lds
    buffer_load_dwordx4 v9, s[12:15], s41 offen offset:3072 lds
    s_add_u32 m0, m0, 4096
    s_nop 0
    buffer_load_dwordx4 v10, s[12:15], s41 offen offset:0 lds
    buffer_load_dwordx4 v11, s[12:15], s41 offen offset:1024 lds
    s_add_u32 m0, s23, 10240
    s_nop 0
    buffer_load_dwordx4 v2, s[8:11], s40 offen offset:0 lds
    buffer_load_dwordx4 v3, s[8:11], s40 offen offset:1024 lds
    buffer_load_dwordx4 v4, s[8:11], s40 offen offset:2048 lds
    buffer_load_dwordx4 v5, s[8:11], s40 offen offset:3072 lds
    s_add_u32 s20, s20, 128
    s_and_b32 s20, s20, 2047
    s_add_u32 s40, s20, 65536
    s_mul_i32 s21, s20, 3072
    s_add_u32 s41, s21, 98304
    s_add_u32 s23, s23, 40960
    s_cmp_ge_u32 s23, 122880
    s_cselect_b32 s35, 122880, 0
    s_sub_u32 s23, s23, s35
    s_waitcnt vmcnt(20)
    s_mov_b32 s26, 14
L_p1_dma_8:
    s_barrier
    s_add_u32 m0, s23, 4096
    s_nop 0
    buffer_load_dwordx4 v6, s[12:15], s21 offen offset:0 lds
    buffer_load_dwordx4 v7, s[12:15], s21 offen offset:1024 lds
    buffer_load_dwordx4 v8, s[12:15], s21 offen offset:2048 lds
    buffer_load_dwordx4 v9, s[12:15], s21 offen offset:3072 lds
    s_add_u32 m0, m0, 4096
    s_nop 0
    buffer_load_dwordx4 v10, s[12:15], s21 offen offset:0 lds
    buffer_load_dwordx4 v11, s[12:15], s21 offen offset:1024 lds
    s_add_u32 m0, s23, 0
    s_nop 0
    buffer_load_dwordx4 v2, s[8:11], s20 offen offset:0 lds
    buffer_load_dwordx4 v3, s[8:11], s20 offen offset:1024 lds
    buffer_load_dwordx4 v4, s[8:11], s20 offen offset:2048 lds
    buffer_load_dwordx4 v5, s[8:11], s20 offen offset:3072 lds
    s_add_u32 m0, s23, 14336
    s_nop 0
    buffer_load_dwordx4 v6, s[12:15], s41 offen offset:0 lds
    buffer_load_dwordx4 v7, s[12:15], s41 offen offset:1024 lds
    buffer_load_dwordx4 v8, s[12:15], s41 offen offset:2048 lds
    buffer_load_dwordx4 v9, s[12:15], s41 offen offset:3072 lds
    s_add_u32 m0, m0, 4096
    s_nop 0
    buffer_load_dwordx4 v10, s[12:15], s41 offen offset:0 lds
    buffer_load_dwordx4 v11, s[12:15], s41 offen offset:1024 lds
    s_add_u32 m0, s23, 10240
    s_nop 0
    buffer_load_dwordx4 v2, s[8:11], s40 offen offset:0 lds
    buffer_load_dwordx4 v3, s[8:11], s40 offen offset:1024 lds
    buffer_load_dwordx4 v4, s[8:11], s40 offen offset:2048 lds
    buffer_load_dwordx4 v5, s[8:11], s40 offen offset:3072 lds
    s_add_u32 s20, s20, 128
    s_and_b32 s20, s20, 2047
    s_add_u32 s40, s20, 65536
    s_mul_i32 s21, s20, 3072
    s_add_u32 s41, s21, 98304
    s_add_u32 s23, s23, 40960
    s_cmp_ge_u32 s23, 122880
    s_cselect_b32 s35, 122880, 0
    s_sub_u32 s23, s23, s35
    s_sub_u32 s26, s26, 1
    s_cmp_lg_u32 s26, 0
    s_waitcnt vmcnt(20)
    s_cbranch_scc1 L_p1_dma_8
    s_barrier
    v_lshlrev_b32 v24, 2, v1
    v_add_u32 v24, 64512, v24
    v_mov_b32 v26, 0
    ds_write_b32 v24, v26
    s_waitcnt lgkmcnt(0)
    s_waitcnt vmcnt(0)
    s_barrier
    v_mov_b32 v143, 0x7ffffff0
L_att:
    s_and_b32 s30, s2, 7
    s_lshr_b32 s31, s2, 3
    s_lshl_b32 s32, s30, 2
    s_lshr_b32 s33, s31, 3
    s_add_u32 s32, s32, s33
    s_and_b32 s33, s31, 7
    s_lshl_b32 s33, s33, 3
    s_add_u32 s33, s33, s22
    v_lshlrev_b32 v4, 4, v1
    v_add_u32 v2, 98304, v4
    s_lshr_b32 s34, s22, 1
    s_and_b32 s35, s22, 1
    s_lshl_b32 s34, s34, 12
    s_cmp_eq_u32 s35, 0
    s_movk_i32 s39, 6144
    s_cselect_b32 s35, 8192, s39
    s_add_u32 s34, s34, s35
    v_add_u32 v3, s34, v4
    v_mov_b32 v7, v4
    s_lshl_b32 s23, s22, 11
    s_add_u32 s23, s23, 98304
    s_lshl_b32 s36, s32, 18
    s_add_u32 s36, s36, 8388608
    s_lshl_b32 s37, s32, 6
    s_add_u32 s37, s37, s33
    s_lshl_b32 s37, s37, 11
    s_lshl_b32 s38, s33, 6
    s_lshl_b32 s39, s32, 1
    s_add_u32 s38, s38, s39
    s_lshl_b32 s38, s38, 10
    s_lshl_b32 s51, s33, 10
    s_lshr_b32 s39, s32, 2
    s_lshl_b32 s39, s39, 7
    s_add_u32 s51, s51, s39
    s_and_b32 s39, s32, 3
    s_lshl_b32 s39, s39, 2
    s_add_u32 s51, s51, s39
    s_add_u32 s51, s51, 688128
    s_add_u32 s8, s46, s36
    s_addc_u32 s9, s47, 0
    s_mov_b32 s10, 262144
    s_mov_b32 s11, 0x20000
    s_add_u32 s12, s46, 4194304
    s_addc_u32 s13, s47, 0
    s_mov_b32 s14, 4194304
    s_mov_b32 s15, 0x20000
    s_add_u32 s16, s46, 16777216
    s_addc_u32 s17, s47, 0
    s_mov_b32 s18, 4194304
    s_mov_b32 s19, 0x20000
    s_add_u32 s24, s46, 20971520
    s_addc_u32 s25, s47, 0
    s_mov_b32 s26, 1048576
    s_mov_b32 s27, 0x20000
    v_and_b32 v4, 3, v1
    v_bfe_u32 v5, v1, 2, 1
    v_mov_b32 v6, 0x3f803f80
    v_cmp_eq_u32 vcc, 0, v4
    s_nop 1
    v_cndmask_b32 v6, 0, v6, vcc
    v_cmp_eq_u32 vcc, 0, v5
    s_nop 1
    v_cndmask_b32 v84, 0, v6, vcc
    v_cndmask_b32 v85, 0, v6, vcc
    v_cndmask_b32 v86, v6, 0, vcc
    v_cndmask_b32 v87, v6, 0, vcc
    v_mov_b32 v88, 0xdddd
    v_mov_b32 v124, 64512
    v_mov_b32 v125, 1
    v_mov_b32 v48, 0
    v_mov_b32 v49, 0
    v_mov_b32 v50, 0
    v_mov_b32 v51, 0
    v_mov_b32 v52, 0
    v_mov_b32 v53, 0
    v_mov_b32 v54, 0
    v_mov_b32 v55, 0
    v_mov_b32 v56, 0
    v_mov_b32 v57, 0
    v_mov_b32 v58, 0
    v_mov_b32 v59, 0
    v_mov_b32 v60, 0
    v_mov_b32 v61, 0
    v_mov_b32 v62, 0
    v_mov_b32 v63, 0
    v_mov_b32 v80, 0
    v_mov_b32 v81, 0
    v_mov_b32 v82, 0
    v_mov_b32 v83, 0
    v_mov_b32 v40, 0
    v_mov_b32 v41, 0
    v_mov_b32 v42, 0
    v_mov_b32 v43, 0
    v_mov_b32 v44, 0
    v_mov_b32 v45, 0
    v_mov_b32 v46, 0
    v_mov_b32 v47, 0
    v_mov_b32 v120, 0
    v_mov_b32 v121, 0
    v_mov_b32 v122, 0
    v_mov_b32 v123, 0
    s_and_b32 s30, s2, 7
    s_lshr_b32 s31, s2, 3
    s_lshr_b32 s32, s30, 1
    s_lshl_b32 s32, s32, 2
    s_and_b32 s33, s31, 3
    s_add_u32 s32, s32, s33
    s_and_b32 s33, s30, 1
    s_lshl_b32 s33, s33, 3
    s_lshr_b32 s34, s31, 2
    s_add_u32 s33, s33, s34
    s_and_b32 s34, s22, 3
    s_lshl_b32 s21, s32, 2
    s_add_u32 s21, s21, s34
    s_lshl_b32 s21, s21, 5
    v_and_b32 v4, 31, v1
    v_add_u32 v148, s21, v4
    v_lshrrev_b32 v5, 5, v1
    s_lshl_b32 s21, s33, 7
    v_lshlrev_b32 v6, 4, v5
    v_add_u32 v149, s21, v6
    v_lshl_add_u32 v147, v148, 11, v149
    s_lshl_b32 s62, s32, 2
    s_add_u32 s62, s62, s34
    s_lshl_b32 s62, s62, 16
    v_bfe_u32 v4, v1, 2, 2
    v_lshl_add_u32 v5, v5, 2, v4
    v_lshlrev_b32 v5, 7, v5
    v_bfe_u32 v6, v1, 4, 1
    v_lshlrev_b32 v6, 1, v6
    v_and_b32 v166, 1, v1
    v_add_u32 v6, v6, v166
    v_lshrrev_b32 v4, 1, v4
    v_lshlrev_b32 v4, 2, v4
    v_xor_b32 v6, v6, v4
    v_lshl_add_u32 v5, v6, 4, v5
    v_bfe_u32 v4, v1, 1, 1
    v_lshl_add_u32 v166, v4, 3, v5
    v_xor_b32 v167, 64, v166
    s_load_dwordx2 s[52:53], s[0:1], 64
    s_mov_b32 s56, s4
    s_mov_b32 s57, s5
    s_mov_b32 s58, 4194304
    s_mov_b32 s59, 0x20000
    s_waitcnt lgkmcnt(0)
    s_cmp_lg_u32 s22, 4
    s_cbranch_scc1 L_nopoll
    v_mov_b32 v4, 64520
    s_mov_b32 s61, 1048576
L_lw_9:
    ds_read_b32 v5, v4
    s_waitcnt lgkmcnt(0)
    v_cmp_gt_u32 vcc, 4, v5
    s_cbranch_vccz L_lwe_10
    s_sleep 2
    s_sub_u32 s61, s61, 1
    s_cmp_lg_u32 s61, 0
    s_cbranch_scc1 L_lw_9
L_lwe_10:
    s_and_b32 s30, s2, 7
    s_lshr_b32 s31, s2, 3
    s_lshl_b32 s32, s30, 2
    s_lshr_b32 s33, s31, 3
    s_add_u32 s32, s32, s33
    s_and_b32 s33, s31, 7
    s_mul_i32 s40, s32, 6144
    s_add_u32 s40, s40, 491520
    s_add_u32 s41, s40, 2048
    s_lshl_b32 s33, s33, 8
    s_add_u32 s40, s40, s33
    v_lshrrev_b32 v4, 1, v1
    v_lshlrev_b32 v4, 7, v4
    v_and_b32 v5, 1, v1
    v_lshl_add_u32 v4, v5, 2, v4
    v_and_b32 v5, 0xff, v4
    s_mov_b32 s61, 262144
L_spin_11:
    buffer_load_dword v6, v4, s[24:27], s41 offen sc1
    buffer_load_dword v127, v5, s[24:27], s40 offen sc1
    s_waitcnt vmcnt(0)
    v_and_b32 v6, v6, v127
    v_cmp_ne_u32 vcc, 1, v6
    s_nop 1
    s_cmp_eq_u64 vcc, 0
    s_cbranch_scc1 L_spun_12
    s_sleep 2
    s_sub_u32 s61, s61, 1
    s_cmp_lg_u32 s61, 0
    s_cbranch_scc1 L_spin_11
L_spun_12:
L_nopoll:
    s_barrier
    buffer_load_dwordx4 v[8:11], v7, s[12:15], s37 offen sc1
    buffer_load_dwordx4 v[12:15], v7, s[12:15], s37 offen offset:1024 sc1
    s_lshl_b32 s39, s22, 10
    s_cmp_ge_u32 s22, 6
    s_cbranch_scc1 L_pro_nt
    s_add_u32 m0, s39, 147456
    s_nop 0
    buffer_load_dwordx4 v7, s[8:11], s39 offen sc1 lds
L_pro_nt:
    s_mov_b32 s20, 16384
    s_mov_b32 s50, 16
    s_waitcnt vmcnt(0)
    s_mov_b64 exec, 1
    ds_add_u32 v124, v125
    s_mov_b64 exec, -1
    s_mov_b32 m0, s23
    s_nop 0
    buffer_load_dwordx4 v3, s[8:11], 0 offen sc1 lds
    buffer_load_dwordx4 v3, s[8:11], 0 offen offset:1024 sc1 lds
    s_add_u32 m0, s23, 16384
    s_nop 0
    buffer_load_dwordx4 v3, s[8:11], s20 offen sc1 lds
    buffer_load_dwordx4 v3, s[8:11], s20 offen offset:1024 sc1 lds
    s_mov_b32 s20, 32768
    s_mov_b32 s61, 1048576
L_lw_13:
    ds_read_b32 v126, v124
    s_waitcnt lgkmcnt(0)
    v_cmp_gt_u32 vcc, 8, v126
    s_cbranch_vccz L_lwe_14
    s_sleep 0
    s_sub_u32 s61, s61, 1
    s_cmp_lg_u32 s61, 0
    s_cbranch_scc1 L_lw_13
L_lwe_14:
    ds_read_b128 v[92:95], v2 offset:49152
    ds_read_b128 v[96:99], v2 offset:50176
    ds_read_b128 v[108:111], v2 offset:51200
    ds_read_b128 v[112:115], v2 offset:52224
    ds_read_b128 v[100:103], v2 offset:53248
    ds_read_b128 v[104:107], v2 offset:54272
    s_waitcnt lgkmcnt(4)
    v_mfma_f32_32x32x16_bf16 v[16:31], v[92:95], v[8:11], 0
    v_mfma_f32_32x32x16_bf16 v[16:31], v[96:99], v[12:15], v[16:31]
    s_waitcnt vmcnt(2)
    s_mov_b64 exec, 1
    ds_add_u32 v124, v125
    s_mov_b64 exec, -1
    s_cmp_ge_u32 s22, 4
    s_cbranch_scc1 L_pl_15
    v_lshlrev_b32 v4, 3, v148
    s_mov_b32 s21, 270336
    buffer_load_dwordx4 v[128:131], v147, s[56:59], 0 offen offset:0
    buffer_load_dwordx4 v[132:135], v147, s[56:59], 0 offen offset:32
    buffer_load_dwordx4 v[136:139], v147, s[56:59], 0 offen offset:64
    buffer_load_dwordx4 v[140:143], v147, s[56:59], 0 offen offset:96
    buffer_load_dwordx2 v[144:145], v4, s[24:27], s21 offen sc1
L_pl_15:
    s_cmp_ge_u32 s22, 4
    s_cbranch_scc1 L_pl_16
    v_and_b32 v4, 15, v1
    v_lshlrev_b32 v4, 2, v4
    s_mov_b32 s21, 262144
    buffer_load_dword v146, v4, s[24:27], s21 offen sc1
L_pl_16:
    s_nop 7
    v_max3_f32 v4, v16, v17, v18
    v_max3_f32 v4, v4, v19, v20
    v_max3_f32 v4, v4, v21, v22
    v_max3_f32 v4, v4, v23, v24
    v_max3_f32 v4, v4, v25, v26
    v_max3_f32 v4, v4, v27, v28
    v_max3_f32 v4, v4, v29, v30
    v_max_f32 v4, v4, v31
    v_mov_b32 v5, v4
    ds_read_b32 v126, v124
    s_nop 0
    v_permlane32_swap_b32 v4, v5
    s_nop 1
    v_max_f32 v4, v4, v5
    v_sub_f32 v4, 0, v4
    v_mov_b32 v5, v4
    v_pk_add_f32 v[16:17], v[16:17], v[4:5]
    v_pk_add_f32 v[18:19], v[18:19], v[4:5]
    v_pk_add_f32 v[20:21], v[20:21], v[4:5]
    v_pk_add_f32 v[22:23], v[22:23], v[4:5]
    v_pk_add_f32 v[24:25], v[24:25], v[4:5]
    v_pk_add_f32 v[26:27], v[26:27], v[4:5]
    v_pk_add_f32 v[28:29], v[28:29], v[4:5]
    v_pk_add_f32 v[30:31], v[30:31], v[4:5]
    v_pk_mov_b32 v[64:65], v[4:5], v[4:5]
    v_pk_mov_b32 v[66:67], v[4:5], v[4:5]
    v_pk_mov_b32 v[68:69], v[4:5], v[4:5]
    v_pk_mov_b32 v[70:71], v[4:5], v[4:5]
    v_pk_mov_b32 v[72:73], v[4:5], v[4:5]
    v_pk_mov_b32 v[74:75], v[4:5], v[4:5]
    v_pk_mov_b32 v[76:77], v[4:5], v[4:5]
    v_pk_mov_b32 v[78:79], v[4:5], v[4:5]
    s_waitcnt lgkmcnt(0)
    s_mov_b32 s49, 4
    .p2align 6
L_att_loop:
    s_setprio 3
    v_exp_f32 v16, v16
    v_exp_f32 v17, v17
    v_smfmac_f32_32x32x32_bf16 v[48:63], v[120:123], v[40:47], v88
    s_waitcnt lgkmcnt(0)
    v_cmp_gt_u32 vcc, s50, v126
    s_add_u32 m0, s23, 32768
    s_cbranch_vccnz L_as_17
L_ar_18:
    s_add_u32 s50, s50, 8
    buffer_load_dwordx4 v3, s[8:11], s20 offen sc1 lds
    buffer_load_dwordx4 v3, s[8:11], s20 offen offset:1024 sc1 lds
    s_add_u32 s20, s20, 16384
    ds_read_b128 v[92:95], v2 offset:0
    v_exp_f32 v18, v18
    v_exp_f32 v19, v19
    v_smfmac_f32_16x16x64_bf16 v[80:83], v[84:87], v[40:47], v88
    ds_read_b128 v[96:99], v2 offset:1024
    v_exp_f32 v20, v20
    v_exp_f32 v21, v21
    v_mfma_f32_32x32x16_bf16 v[32:47], v[100:103], v[8:11], v[64:79]
    ds_read_b128 v[116:119], v2 offset:2048
    v_exp_f32 v22, v22
    v_exp_f32 v23, v23
    v_exp_f32 v24, v24
    v_exp_f32 v25, v25
    v_mfma_f32_32x32x16_bf16 v[32:47], v[104:107], v[12:15], v[32:47]
    ds_read_b128 v[120:123], v2 offset:3072
    v_exp_f32 v26, v26
    v_exp_f32 v27, v27
    v_exp_f32 v28, v28
    v_smfmac_f32_32x32x32_bf16 v[48:63], v[108:111], v[16:23], v88
    v_exp_f32 v29, v29
    v_exp_f32 v30, v30
    v_exp_f32 v31, v31
    v_smfmac_f32_16x16x64_bf16 v[80:83], v[84:87], v[16:23], v88
    s_setprio 2
    v_exp_f32 v32, v32
    v_exp_f32 v33, v33
    v_smfmac_f32_32x32x32_bf16 v[48:63], v[112:115], v[24:31], v88
    ds_read_b128 v[100:103], v2 offset:4096
    v_exp_f32 v34, v34
    v_exp_f32 v35, v35
    v_smfmac_f32_16x16x64_bf16 v[80:83], v[84:87], v[24:31], v88
    ds_read_b128 v[104:107], v2 offset:5120
    v_exp_f32 v36, v36
    v_exp_f32 v37, v37
    s_waitcnt lgkmcnt(2)
    v_mfma_f32_32x32x16_bf16 v[16:31], v[92:95], v[8:11], v[64:79]
    ds_read_b128 v[108:111], v2 offset:6144
    v_exp_f32 v38, v38
    v_exp_f32 v39, v39
    v_exp_f32 v40, v40
    v_exp_f32 v41, v41
    v_mfma_f32_32x32x16_bf16 v[16:31], v[96:99], v[12:15], v[16:31]
    ds_read_b128 v[112:115], v2 offset:7168
    v_exp_f32 v42, v42
    v_exp_f32 v43, v43
    v_exp_f32 v44, v44
    v_smfmac_f32_32x32x32_bf16 v[48:63], v[116:119], v[32:39], v88
    s_waitcnt vmcnt(2)
    s_mov_b64 exec, 1
    ds_add_u32 v124, v125
    s_mov_b64 exec, -1
    v_exp_f32 v45, v45
    v_exp_f32 v46, v46
    v_exp_f32 v47, v47
    v_smfmac_f32_16x16x64_bf16 v[80:83], v[84:87], v[32:39], v88
    s_setprio 1
    v_exp_f32 v16, v16
    v_exp_f32 v17, v17
    v_smfmac_f32_32x32x32_bf16 v[48:63], v[120:123], v[40:47], v88
    ds_read_b128 v[92:95], v2 offset:8192
    v_exp_f32 v18, v18
    v_exp_f32 v19, v19
    v_smfmac_f32_16x16x64_bf16 v[80:83], v[84:87], v[40:47], v88
    ds_read_b128 v[96:99], v2 offset:9216
    v_exp_f32 v20, v20
    v_exp_f32 v21, v21
    s_waitcnt lgkmcnt(2)
    v_mfma_f32_32x32x16_bf16 v[32:47], v[100:103], v[8:11], v[64:79]
    ds_read_b128 v[116:119], v2 offset:10240
    v_exp_f32 v22, v22
    v_exp_f32 v23, v23
    v_exp_f32 v24, v24
    v_exp_f32 v25, v25
    v_mfma_f32_32x32x16_bf16 v[32:47], v[104:107], v[12:15], v[32:47]
    ds_read_b128 v[120:123], v2 offset:11264
    v_exp_f32 v26, v26
    v_exp_f32 v27, v27
    v_exp_f32 v28, v28
    v_smfmac_f32_32x32x32_bf16 v[48:63], v[108:111], v[16:23], v88
    v_exp_f32 v29, v29
    v_exp_f32 v30, v30
    v_exp_f32 v31, v31
    v_smfmac_f32_16x16x64_bf16 v[80:83], v[84:87], v[16:23], v88
    s_setprio 0
    v_exp_f32 v32, v32
    v_exp_f32 v33, v33
    v_smfmac_f32_32x32x32_bf16 v[48:63], v[112:115], v[24:31], v88
    ds_read_b128 v[100:103], v2 offset:12288
    v_exp_f32 v34, v34
    v_exp_f32 v35, v35
    v_smfmac_f32_16x16x64_bf16 v[80:83], v[84:87], v[24:31], v88
    ds_read_b128 v[104:107], v2 offset:13312
    v_exp_f32 v36, v36
    v_exp_f32 v37, v37
    s_waitcnt lgkmcnt(2)
    v_mfma_f32_32x32x16_bf16 v[16:31], v[92:95], v[8:11], v[64:79]
    ds_read_b128 v[108:111], v2 offset:14336
    v_exp_f32 v38, v38
    v_exp_f32 v39, v39
    v_exp_f32 v40, v40
    v_exp_f32 v41, v41
    v_mfma_f32_32x32x16_bf16 v[16:31], v[96:99], v[12:15], v[16:31]
    ds_read_b128 v[112:115], v2 offset:15360
    v_exp_f32 v42, v42
    v_exp_f32 v43, v43
    v_exp_f32 v44, v44
    v_smfmac_f32_32x32x32_bf16 v[48:63], v[116:119], v[32:39], v88
    ds_read_b32 v126, v124
    v_exp_f32 v45, v45
    v_exp_f32 v46, v46
    v_exp_f32 v47, v47
    v_smfmac_f32_16x16x64_bf16 v[80:83], v[84:87], v[32:39], v88
    s_setprio 3
    v_exp_f32 v16, v16
    v_exp_f32 v17, v17
    v_smfmac_f32_32x32x32_bf16 v[48:63], v[120:123], v[40:47], v88
    s_waitcnt lgkmcnt(0)
    v_cmp_gt_u32 vcc, s50, v126
    s_add_u32 m0, s23, 49152
    s_cbranch_vccnz L_as_20
L_ar_21:
    s_add_u32 s50, s50, 8
    buffer_load_dwordx4 v3, s[8:11], s20 offen sc1 lds
    buffer_load_dwordx4 v3, s[8:11], s20 offen offset:1024 sc1 lds
    s_add_u32 s20, s20, 16384
    ds_read_b128 v[92:95], v2 offset:16384
    v_exp_f32 v18, v18
    v_exp_f32 v19, v19
    v_smfmac_f32_16x16x64_bf16 v[80:83], v[84:87], v[40:47], v88
    ds_read_b128 v[96:99], v2 offset:17408
    v_exp_f32 v20, v20
    v_exp_f32 v21, v21
    v_mfma_f32_32x32x16_bf16 v[32:47], v[100:103], v[8:11], v[64:79]
    ds_read_b128 v[116:119], v2 offset:18432
    v_exp_f32 v22, v22
    v_exp_f32 v23, v23
    v_exp_f32 v24, v24
    v_exp_f32 v25, v25
    v_mfma_f32_32x32x16_bf16 v[32:47], v[104:107], v[12:15], v[32:47]
    ds_read_b128 v[120:123], v2 offset:19456
    v_exp_f32 v26, v26
    v_exp_f32 v27, v27
    v_exp_f32 v28, v28
    v_smfmac_f32_32x32x32_bf16 v[48:63], v[108:111], v[16:23], v88
    v_exp_f32 v29, v29
    v_exp_f32 v30, v30
    v_exp_f32 v31, v31
    v_smfmac_f32_16x16x64_bf16 v[80:83], v[84:87], v[16:23], v88
    s_setprio 2
    v_exp_f32 v32, v32
    v_exp_f32 v33, v33
    v_smfmac_f32_32x32x32_bf16 v[48:63], v[112:115], v[24:31], v88
    ds_read_b128 v[100:103], v2 offset:20480
    v_exp_f32 v34, v34
    v_exp_f32 v35, v35
    v_smfmac_f32_16x16x64_bf16 v[80:83], v[84:87], v[24:31], v88
    ds_read_b128 v[104:107], v2 offset:21504
    v_exp_f32 v36, v36
    v_exp_f32 v37, v37
    s_waitcnt lgkmcnt(2)
    v_mfma_f32_32x32x16_bf16 v[16:31], v[92:95], v[8:11], v[64:79]
    ds_read_b128 v[108:111], v2 offset:22528
    v_exp_f32 v38, v38
    v_exp_f32 v39, v39
    v_exp_f32 v40, v40
    v_exp_f32 v41, v41
    v_mfma_f32_32x32x16_bf16 v[16:31], v[96:99], v[12:15], v[16:31]
    ds_read_b128 v[112:115], v2 offset:23552
    v_exp_f32 v42, v42
    v_exp_f32 v43, v43
    v_exp_f32 v44, v44
    v_smfmac_f32_32x32x32_bf16 v[48:63], v[116:119], v[32:39], v88
    s_waitcnt vmcnt(2)
    s_mov_b64 exec, 1
    ds_add_u32 v124, v125
    s_mov_b64 exec, -1
    v_exp_f32 v45, v45
    v_exp_f32 v46, v46
    v_exp_f32 v47, v47
    v_smfmac_f32_16x16x64_bf16 v[80:83], v[84:87], v[32:39], v88
    s_setprio 1
    v_exp_f32 v16, v16
    v_exp_f32 v17, v17
    v_smfmac_f32_32x32x32_bf16 v[48:63], v[120:123], v[40:47], v88
    ds_read_b128 v[92:95], v2 offset:24576
    v_exp_f32 v18, v18
    v_exp_f32 v19, v19
    v_smfmac_f32_16x16x64_bf16 v[80:83], v[84:87], v[40:47], v88
    ds_read_b128 v[96:99], v2 offset:25600
    v_exp_f32 v20, v20
    v_exp_f32 v21, v21
    s_waitcnt lgkmcnt(2)
    v_mfma_f32_32x32x16_bf16 v[32:47], v[100:103], v[8:11], v[64:79]
    ds_read_b128 v[116:119], v2 offset:26624
    v_exp_f32 v22, v22
    v_exp_f32 v23, v23
    v_exp_f32 v24, v24
    v_exp_f32 v25, v25
    v_mfma_f32_32x32x16_bf16 v[32:47], v[104:107], v[12:15], v[32:47]
    ds_read_b128 v[120:123], v2 offset:27648
    v_exp_f32 v26, v26
    v_exp_f32 v27, v27
    v_exp_f32 v28, v28
    v_smfmac_f32_32x32x32_bf16 v[48:63], v[108:111], v[16:23], v88
    v_exp_f32 v29, v29
    v_exp_f32 v30, v30
    v_exp_f32 v31, v31
    v_smfmac_f32_16x16x64_bf16 v[80:83], v[84:87], v[16:23], v88
    s_setprio 0
    v_exp_f32 v32, v32
    v_exp_f32 v33, v33
    v_smfmac_f32_32x32x32_bf16 v[48:63], v[112:115], v[24:31], v88
    ds_read_b128 v[100:103], v2 offset:28672
    v_exp_f32 v34, v34
    v_exp_f32 v35, v35
    v_smfmac_f32_16x16x64_bf16 v[80:83], v[84:87], v[24:31], v88
    ds_read_b128 v[104:107], v2 offset:29696
    v_exp_f32 v36, v36
    v_exp_f32 v37, v37
    s_waitcnt lgkmcnt(2)
    v_mfma_f32_32x32x16_bf16 v[16:31], v[92:95], v[8:11], v[64:79]
    ds_read_b128 v[108:111], v2 offset:30720
    v_exp_f32 v38, v38
    v_exp_f32 v39, v39
    v_exp_f32 v40, v40
    v_exp_f32 v41, v41
    v_mfma_f32_32x32x16_bf16 v[16:31], v[96:99], v[12:15], v[16:31]
    ds_read_b128 v[112:115], v2 offset:31744
    v_exp_f32 v42, v42
    v_exp_f32 v43, v43
    v_exp_f32 v44, v44
    v_smfmac_f32_32x32x32_bf16 v[48:63], v[116:119], v[32:39], v88
    ds_read_b32 v126, v124
    v_exp_f32 v45, v45
    v_exp_f32 v46, v46
    v_exp_f32 v47, v47
    v_smfmac_f32_16x16x64_bf16 v[80:83], v[84:87], v[32:39], v88
    s_setprio 3
    v_exp_f32 v16, v16
    v_exp_f32 v17, v17
    v_smfmac_f32_32x32x32_bf16 v[48:63], v[120:123], v[40:47], v88
    s_waitcnt lgkmcnt(0)
    v_cmp_gt_u32 vcc, s50, v126
    s_add_u32 m0, s23, 0
    s_cbranch_vccnz L_as_23
L_ar_24:
    s_add_u32 s50, s50, 8
    s_cmp_eq_u32 s49, 1
    s_cbranch_scc1 L_ad_25
    buffer_load_dwordx4 v3, s[8:11], s20 offen sc1 lds
    buffer_load_dwordx4 v3, s[8:11], s20 offen offset:1024 sc1 lds
    s_add_u32 s20, s20, 16384
L_ad_25:
    ds_read_b128 v[92:95], v2 offset:32768
    v_exp_f32 v18, v18
    v_exp_f32 v19, v19
    v_smfmac_f32_16x16x64_bf16 v[80:83], v[84:87], v[40:47], v88
    ds_read_b128 v[96:99], v2 offset:33792
    v_exp_f32 v20, v20
    v_exp_f32 v21, v21
    v_mfma_f32_32x32x16_bf16 v[32:47], v[100:103], v[8:11], v[64:79]
    ds_read_b128 v[116:119], v2 offset:34816
    v_exp_f32 v22, v22
    v_exp_f32 v23, v23
    v_exp_f32 v24, v24
    v_exp_f32 v25, v25
    v_mfma_f32_32x32x16_bf16 v[32:47], v[104:107], v[12:15], v[32:47]
    ds_read_b128 v[120:123], v2 offset:35840
    v_exp_f32 v26, v26
    v_exp_f32 v27, v27
    v_exp_f32 v28, v28
    v_smfmac_f32_32x32x32_bf16 v[48:63], v[108:111], v[16:23], v88
    v_exp_f32 v29, v29
    v_exp_f32 v30, v30
    v_exp_f32 v31, v31
    v_smfmac_f32_16x16x64_bf16 v[80:83], v[84:87], v[16:23], v88
    s_setprio 2
    v_exp_f32 v32, v32
    v_exp_f32 v33, v33
    v_smfmac_f32_32x32x32_bf16 v[48:63], v[112:115], v[24:31], v88
    ds_read_b128 v[100:103], v2 offset:36864
    v_exp_f32 v34, v34
    v_exp_f32 v35, v35
    v_smfmac_f32_16x16x64_bf16 v[80:83], v[84:87], v[24:31], v88
    ds_read_b128 v[104:107], v2 offset:37888
    v_exp_f32 v36, v36
    v_exp_f32 v37, v37
    s_waitcnt lgkmcnt(2)
    v_mfma_f32_32x32x16_bf16 v[16:31], v[92:95], v[8:11], v[64:79]
    ds_read_b128 v[108:111], v2 offset:38912
    v_exp_f32 v38, v38
    v_exp_f32 v39, v39
    v_exp_f32 v40, v40
    v_exp_f32 v41, v41
    v_mfma_f32_32x32x16_bf16 v[16:31], v[96:99], v[12:15], v[16:31]
    ds_read_b128 v[112:115], v2 offset:39936
    v_exp_f32 v42, v42
    v_exp_f32 v43, v43
    v_exp_f32 v44, v44
    v_smfmac_f32_32x32x32_bf16 v[48:63], v[116:119], v[32:39], v88
    s_waitcnt vmcnt(2)
    s_cmp_eq_u32 s49, 1
    s_cbranch_scc0 L_aw_26
    s_waitcnt vmcnt(0)
L_aw_26:
    s_mov_b64 exec, 1
    ds_add_u32 v124, v125
    s_mov_b64 exec, -1
    v_exp_f32 v45, v45
    v_exp_f32 v46, v46
    v_exp_f32 v47, v47
    v_smfmac_f32_16x16x64_bf16 v[80:83], v[84:87], v[32:39], v88
    s_setprio 1
    v_exp_f32 v16, v16
    v_exp_f32 v17, v17
    v_smfmac_f32_32x32x32_bf16 v[48:63], v[120:123], v[40:47], v88
    ds_read_b128 v[92:95], v2 offset:40960
    v_exp_f32 v18, v18
    v_exp_f32 v19, v19
    v_smfmac_f32_16x16x64_bf16 v[80:83], v[84:87], v[40:47], v88
    ds_read_b128 v[96:99], v2 offset:41984
    v_exp_f32 v20, v20
    v_exp_f32 v21, v21
    s_waitcnt lgkmcnt(2)
    v_mfma_f32_32x32x16_bf16 v[32:47], v[100:103], v[8:11], v[64:79]
    ds_read_b128 v[116:119], v2 offset:43008
    v_exp_f32 v22, v22
    v_exp_f32 v23, v23
    v_exp_f32 v24, v24
    v_exp_f32 v25, v25
    v_mfma_f32_32x32x16_bf16 v[32:47], v[104:107], v[12:15], v[32:47]
    ds_read_b128 v[120:123], v2 offset:44032
    v_exp_f32 v26, v26
    v_exp_f32 v27, v27
    v_exp_f32 v28, v28
    v_smfmac_f32_32x32x32_bf16 v[48:63], v[108:111], v[16:23], v88
    v_exp_f32 v29, v29
    v_exp_f32 v30, v30
    v_exp_f32 v31, v31
    v_smfmac_f32_16x16x64_bf16 v[80:83], v[84:87], v[16:23], v88
    s_setprio 0
    v_exp_f32 v32, v32
    v_exp_f32 v33, v33
    v_smfmac_f32_32x32x32_bf16 v[48:63], v[112:115], v[24:31], v88
    ds_read_b128 v[100:103], v2 offset:45056
    v_exp_f32 v34, v34
    v_exp_f32 v35, v35
    v_smfmac_f32_16x16x64_bf16 v[80:83], v[84:87], v[24:31], v88
    ds_read_b128 v[104:107], v2 offset:46080
    v_exp_f32 v36, v36
    v_exp_f32 v37, v37
    s_waitcnt lgkmcnt(2)
    v_mfma_f32_32x32x16_bf16 v[16:31], v[92:95], v[8:11], v[64:79]
    ds_read_b128 v[108:111], v2 offset:47104
    v_exp_f32 v38, v38
    v_exp_f32 v39, v39
    v_exp_f32 v40, v40
    v_exp_f32 v41, v41
    v_mfma_f32_32x32x16_bf16 v[16:31], v[96:99], v[12:15], v[16:31]
    ds_read_b128 v[112:115], v2 offset:48128
    v_exp_f32 v42, v42
    v_exp_f32 v43, v43
    v_exp_f32 v44, v44
    v_smfmac_f32_32x32x32_bf16 v[48:63], v[116:119], v[32:39], v88
    ds_read_b32 v126, v124
    v_exp_f32 v45, v45
    v_exp_f32 v46, v46
    v_exp_f32 v47, v47
    v_smfmac_f32_16x16x64_bf16 v[80:83], v[84:87], v[32:39], v88
    s_setprio 3
    v_exp_f32 v16, v16
    v_exp_f32 v17, v17
    v_smfmac_f32_32x32x32_bf16 v[48:63], v[120:123], v[40:47], v88
    s_waitcnt lgkmcnt(0)
    v_cmp_gt_u32 vcc, s50, v126
    s_add_u32 m0, s23, 16384
    s_cbranch_vccnz L_as_27
L_ar_28:
    s_add_u32 s50, s50, 8
    s_cmp_eq_u32 s49, 1
    s_cbranch_scc1 L_ad_29
    buffer_load_dwordx4 v3, s[8:11], s20 offen sc1 lds
    buffer_load_dwordx4 v3, s[8:11], s20 offen offset:1024 sc1 lds
    s_add_u32 s20, s20, 16384
L_ad_29:
    ds_read_b128 v[92:95], v2 offset:49152
    v_exp_f32 v18, v18
    v_exp_f32 v19, v19
    v_smfmac_f32_16x16x64_bf16 v[80:83], v[84:87], v[40:47], v88
    ds_read_b128 v[96:99], v2 offset:50176
    v_exp_f32 v20, v20
    v_exp_f32 v21, v21
    v_mfma_f32_32x32x16_bf16 v[32:47], v[100:103], v[8:11], v[64:79]
    ds_read_b128 v[116:119], v2 offset:51200
    v_exp_f32 v22, v22
    v_exp_f32 v23, v23
    v_exp_f32 v24, v24
    v_exp_f32 v25, v25
    v_mfma_f32_32x32x16_bf16 v[32:47], v[104:107], v[12:15], v[32:47]
    ds_read_b128 v[120:123], v2 offset:52224
    v_exp_f32 v26, v26
    v_exp_f32 v27, v27
    v_exp_f32 v28, v28
    v_smfmac_f32_32x32x32_bf16 v[48:63], v[108:111], v[16:23], v88
    v_exp_f32 v29, v29
    v_exp_f32 v30, v30
    v_exp_f32 v31, v31
    v_smfmac_f32_16x16x64_bf16 v[80:83], v[84:87], v[16:23], v88
    s_setprio 2
    v_exp_f32 v32, v32
    v_exp_f32 v33, v33
    v_smfmac_f32_32x32x32_bf16 v[48:63], v[112:115], v[24:31], v88
    ds_read_b128 v[100:103], v2 offset:53248
    v_exp_f32 v34, v34
    v_exp_f32 v35, v35
    v_smfmac_f32_16x16x64_bf16 v[80:83], v[84:87], v[24:31], v88
    ds_read_b128 v[104:107], v2 offset:54272
    v_exp_f32 v36, v36
    v_exp_f32 v37, v37
    s_waitcnt lgkmcnt(2)
    v_mfma_f32_32x32x16_bf16 v[16:31], v[92:95], v[8:11], v[64:79]
    ds_read_b128 v[108:111], v2 offset:55296
    v_exp_f32 v38, v38
    v_exp_f32 v39, v39
    v_exp_f32 v40, v40
    v_exp_f32 v41, v41
    v_mfma_f32_32x32x16_bf16 v[16:31], v[96:99], v[12:15], v[16:31]
    ds_read_b128 v[112:115], v2 offset:56320
    v_exp_f32 v42, v42
    v_exp_f32 v43, v43
    v_exp_f32 v44, v44
    v_smfmac_f32_32x32x32_bf16 v[48:63], v[116:119], v[32:39], v88
    s_waitcnt vmcnt(2)
    s_mov_b64 exec, 1
    ds_add_u32 v124, v125
    s_mov_b64 exec, -1
    v_exp_f32 v45, v45
    v_exp_f32 v46, v46
    v_exp_f32 v47, v47
    v_smfmac_f32_16x16x64_bf16 v[80:83], v[84:87], v[32:39], v88
    s_setprio 1
    v_exp_f32 v16, v16
    v_exp_f32 v17, v17
    v_smfmac_f32_32x32x32_bf16 v[48:63], v[120:123], v[40:47], v88
    ds_read_b128 v[92:95], v2 offset:57344
    v_exp_f32 v18, v18
    v_exp_f32 v19, v19
    v_smfmac_f32_16x16x64_bf16 v[80:83], v[84:87], v[40:47], v88
    ds_read_b128 v[96:99], v2 offset:58368
    v_exp_f32 v20, v20
    v_exp_f32 v21, v21
    s_waitcnt lgkmcnt(2)
    v_mfma_f32_32x32x16_bf16 v[32:47], v[100:103], v[8:11], v[64:79]
    ds_read_b128 v[116:119], v2 offset:59392
    v_exp_f32 v22, v22
    v_exp_f32 v23, v23
    v_exp_f32 v24, v24
    v_exp_f32 v25, v25
    v_mfma_f32_32x32x16_bf16 v[32:47], v[104:107], v[12:15], v[32:47]
    ds_read_b128 v[120:123], v2 offset:60416
    v_exp_f32 v26, v26
    v_exp_f32 v27, v27
    v_exp_f32 v28, v28
    v_smfmac_f32_32x32x32_bf16 v[48:63], v[108:111], v[16:23], v88
    v_exp_f32 v29, v29
    v_exp_f32 v30, v30
    v_exp_f32 v31, v31
    v_smfmac_f32_16x16x64_bf16 v[80:83], v[84:87], v[16:23], v88
    s_setprio 0
    v_exp_f32 v32, v32
    v_exp_f32 v33, v33
    v_smfmac_f32_32x32x32_bf16 v[48:63], v[112:115], v[24:31], v88
    ds_read_b128 v[100:103], v2 offset:61440
    v_exp_f32 v34, v34
    v_exp_f32 v35, v35
    v_smfmac_f32_16x16x64_bf16 v[80:83], v[84:87], v[24:31], v88
    ds_read_b128 v[104:107], v2 offset:62464
    v_exp_f32 v36, v36
    v_exp_f32 v37, v37
    s_waitcnt lgkmcnt(2)
    v_mfma_f32_32x32x16_bf16 v[16:31], v[92:95], v[8:11], v[64:79]
    ds_read_b128 v[108:111], v2 offset:63488
    v_exp_f32 v38, v38
    v_exp_f32 v39, v39
    v_exp_f32 v40, v40
    v_exp_f32 v41, v41
    v_mfma_f32_32x32x16_bf16 v[16:31], v[96:99], v[12:15], v[16:31]
    ds_read_b128 v[112:115], v2 offset:64512
    v_exp_f32 v42, v42
    v_exp_f32 v43, v43
    v_exp_f32 v44, v44
    v_smfmac_f32_32x32x32_bf16 v[48:63], v[116:119], v[32:39], v88
    ds_read_b32 v126, v124
    v_exp_f32 v45, v45
    v_exp_f32 v46, v46
    v_exp_f32 v47, v47
    v_smfmac_f32_16x16x64_bf16 v[80:83], v[84:87], v[32:39], v88
    s_sub_u32 s49, s49, 1
    s_cmp_lg_u32 s49, 0
    s_cbranch_scc1 L_att_loop
L_c_tail:
    s_setprio 0
    s_mov_b32 s56, 0
    s_mov_b32 s55, 0
    s_cmp_ge_u32 s22, 4
    s_cbranch_scc1 L_h_back
    v_min3_u32 v4, v146, v144, v145
    v_cmp_eq_u32 s[40:41], 0, v4
    v_add_u32 v4, -1, v146
    v_lshlrev_b32 v4, 5, v4
    v_lshrrev_b32 v4, 10, v4
    v_lshrrev_b32 v5, 5, v148
    v_cmp_eq_u32 vcc, v4, v5
    s_nop 1
    s_and_b32 s56, vcc_lo, 0xff
    s_or_b32 s40, s40, s41
    s_or_b32 s40, s40, s56
    s_cbranch_scc1 L_h_slow
L_h_back:
    v_smfmac_f32_32x32x32_bf16 v[48:63], v[120:123], v[40:47], v88
    v_smfmac_f32_16x16x64_bf16 v[80:83], v[84:87], v[40:47], v88
    s_waitcnt lgkmcnt(0)
    s_nop 15
    s_nop 3
    v_mov_b32 v4, v80
    v_mov_b32 v5, 0
    v_fma_f32 v5, v48, 0, v5
    v_fma_f32 v5, v49, 0, v5
    v_fma_f32 v5, v50, 0, v5
    v_fma_f32 v5, v51, 0, v5
    v_fma_f32 v5, v52, 0, v5
    v_fma_f32 v5, v53, 0, v5
    v_fma_f32 v5, v54, 0, v5
    v_fma_f32 v5, v55, 0, v5
    v_fma_f32 v5, v56, 0, v5
    v_fma_f32 v5, v57, 0, v5
    v_fma_f32 v5, v58, 0, v5
    v_fma_f32 v5, v59, 0, v5
    v_fma_f32 v5, v60, 0, v5
    v_fma_f32 v5, v61, 0, v5
    v_fma_f32 v5, v62, 0, v5
    v_fma_f32 v5, v63, 0, v5
    v_cmp_u_f32 vcc, v5, v5
    v_mov_b32 v6, 0x5f800000
    v_cmp_nle_f32 s[40:41], v4, v6
    s_nop 1
    s_or_b64 vcc, vcc, s[40:41]
    s_cbranch_vccnz L_att_slow
L_att_fin:
    v_rcp_f32 v4, v4
    s_nop 0
    v_mul_f32 v48, v48, v4
    v_mul_f32 v49, v49, v4
    v_mul_f32 v50, v50, v4
    v_mul_f32 v51, v51, v4
    v_mul_f32 v52, v52, v4
    v_mul_f32 v53, v53, v4
    v_mul_f32 v54, v54, v4
    v_mul_f32 v55, v55, v4
    v_mul_f32 v56, v56, v4
    v_mul_f32 v57, v57, v4
    v_mul_f32 v58, v58, v4
    v_mul_f32 v59, v59, v4
    v_mul_f32 v60, v60, v4
    v_mul_f32 v61, v61, v4
    v_mul_f32 v62, v62, v4
    v_mul_f32 v63, v63, v4
    v_cvt_pk_bf16_f32 v16, v48, v49
    v_cvt_pk_bf16_f32 v17, v50, v51
    v_cvt_pk_bf16_f32 v18, v52, v53
    v_cvt_pk_bf16_f32 v19, v54, v55
    v_cvt_pk_bf16_f32 v20, v56, v57
    v_cvt_pk_bf16_f32 v21, v58, v59
    v_cvt_pk_bf16_f32 v22, v60, v61
    v_cvt_pk_bf16_f32 v23, v62, v63
    buffer_store_dwordx4 v[16:19], v7, s[16:19], s38 offen sc1
    buffer_store_dwordx4 v[20:23], v7, s[16:19], s38 offen offset:1024 sc1
    v_mov_b32 v88, v124
    v_mov_b32 v89, 1
    s_cmp_lt_u32 s22, 4
    s_cbranch_scc1 L_p3_go
    s_waitcnt vmcnt(0)
    s_mov_b64 exec, 1
    buffer_store_dword v89, off, s[24:27], s51 sc1
    ds_add_u32 v88, v89
    s_waitcnt vmcnt(0) lgkmcnt(0)
    s_branch L_done
L_p3_go:
    v_mov_b32 v3, v147
    v_mov_b32 v14, 64528
    v_mov_b32 v2, v166
    v_mov_b32 v6, v167
    s_cmp_lg_u32 s55, 0
    s_cbranch_scc1 L_p3_gsel
    v_mul_f32 v96, v144, v145
    v_sub_f32 v96, 0, v96
    v_mov_b32 v97, v145
    v_lshlrev_b32 v8, 16, v128
    v_and_b32 v9, 0xffff0000, v128
    v_lshlrev_b32 v10, 16, v129
    v_and_b32 v11, 0xffff0000, v129
    v_fma_f32 v8, v8, v97, v96
    v_fma_f32 v9, v9, v97, v96
    v_fma_f32 v10, v10, v97, v96
    v_fma_f32 v11, v11, v97, v96
    v_mul_f32 v12, 0xbfb8aa3b, v8
    v_mul_f32 v15, 0xbfb8aa3b, v9
    v_mul_f32 v4, 0xbfb8aa3b, v10
    v_mul_f32 v5, 0xbfb8aa3b, v11
    v_exp_f32 v12, v12
    v_exp_f32 v15, v15
    v_exp_f32 v4, v4
    v_exp_f32 v5, v5
    v_add_f32 v12, 1.0, v12
    v_add_f32 v15, 1.0, v15
    v_add_f32 v4, 1.0, v4
    v_add_f32 v5, 1.0, v5
    v_rcp_f32 v12, v12
    v_rcp_f32 v15, v15
    v_rcp_f32 v4, v4
    v_rcp_f32 v5, v5
    v_mul_f32 v8, v8, v12
    v_mul_f32 v9, v9, v15
    v_mul_f32 v10, v10, v4
    v_mul_f32 v11, v11, v5
    v_cvt_pk_bf16_f32 v150, v8, v9
    v_cvt_pk_bf16_f32 v151, v10, v11
    v_lshlrev_b32 v8, 16, v130
    v_and_b32 v9, 0xffff0000, v130
    v_lshlrev_b32 v10, 16, v131
    v_and_b32 v11, 0xffff0000, v131
    v_fma_f32 v8, v8, v97, v96
    v_fma_f32 v9, v9, v97, v96
    v_fma_f32 v10, v10, v97, v96
    v_fma_f32 v11, v11, v97, v96
    v_mul_f32 v12, 0xbfb8aa3b, v8
    v_mul_f32 v15, 0xbfb8aa3b, v9
    v_mul_f32 v4, 0xbfb8aa3b, v10
    v_mul_f32 v5, 0xbfb8aa3b, v11
    v_exp_f32 v12, v12
    v_exp_f32 v15, v15
    v_exp_f32 v4, v4
    v_exp_f32 v5, v5
    v_add_f32 v12, 1.0, v12
    v_add_f32 v15, 1.0, v15
    v_add_f32 v4, 1.0, v4
    v_add_f32 v5, 1.0, v5
    v_rcp_f32 v12, v12
    v_rcp_f32 v15, v15
    v_rcp_f32 v4, v4
    v_rcp_f32 v5, v5
    v_mul_f32 v8, v8, v12
    v_mul_f32 v9, v9, v15
    v_mul_f32 v10, v10, v4
    v_mul_f32 v11, v11, v5
    v_cvt_pk_bf16_f32 v152, v8, v9
    v_cvt_pk_bf16_f32 v153, v10, v11
    v_lshlrev_b32 v8, 16, v132
    v_and_b32 v9, 0xffff0000, v132
    v_lshlrev_b32 v10, 16, v133
    v_and_b32 v11, 0xffff0000, v133
    v_fma_f32 v8, v8, v97, v96
    v_fma_f32 v9, v9, v97, v96
    v_fma_f32 v10, v10, v97, v96
    v_fma_f32 v11, v11, v97, v96
    v_mul_f32 v12, 0xbfb8aa3b, v8
    v_mul_f32 v15, 0xbfb8aa3b, v9
    v_mul_f32 v4, 0xbfb8aa3b, v10
    v_mul_f32 v5, 0xbfb8aa3b, v11
    v_exp_f32 v12, v12
    v_exp_f32 v15, v15
    v_exp_f32 v4, v4
    v_exp_f32 v5, v5
    v_add_f32 v12, 1.0, v12
    v_add_f32 v15, 1.0, v15
    v_add_f32 v4, 1.0, v4
    v_add_f32 v5, 1.0, v5
    v_rcp_f32 v12, v12
    v_rcp_f32 v15, v15
    v_rcp_f32 v4, v4
    v_rcp_f32 v5, v5
    v_mul_f32 v8, v8, v12
    v_mul_f32 v9, v9, v15
    v_mul_f32 v10, v10, v4
    v_mul_f32 v11, v11, v5
    v_cvt_pk_bf16_f32 v154, v8, v9
    v_cvt_pk_bf16_f32 v155, v10, v11
    v_lshlrev_b32 v8, 16, v134
    v_and_b32 v9, 0xffff0000, v134
    v_lshlrev_b32 v10, 16, v135
    v_and_b32 v11, 0xffff0000, v135
    v_fma_f32 v8, v8, v97, v96
    v_fma_f32 v9, v9, v97, v96
    v_fma_f32 v10, v10, v97, v96
    v_fma_f32 v11, v11, v97, v96
    v_mul_f32 v12, 0xbfb8aa3b, v8
    v_mul_f32 v15, 0xbfb8aa3b, v9
    v_mul_f32 v4, 0xbfb8aa3b, v10
    v_mul_f32 v5, 0xbfb8aa3b, v11
    v_exp_f32 v12, v12
    v_exp_f32 v15, v15
    v_exp_f32 v4, v4
    v_exp_f32 v5, v5
    v_add_f32 v12, 1.0, v12
    v_add_f32 v15, 1.0, v15
    v_add_f32 v4, 1.0, v4
    v_add_f32 v5, 1.0, v5
    v_rcp_f32 v12, v12
    v_rcp_f32 v15, v15
    v_rcp_f32 v4, v4
    v_rcp_f32 v5, v5
    v_mul_f32 v8, v8, v12
    v_mul_f32 v9, v9, v15
    v_mul_f32 v10, v10, v4
    v_mul_f32 v11, v11, v5
    v_cvt_pk_bf16_f32 v156, v8, v9
    v_cvt_pk_bf16_f32 v157, v10, v11
    v_lshlrev_b32 v8, 16, v136
    v_and_b32 v9, 0xffff0000, v136
    v_lshlrev_b32 v10, 16, v137
    v_and_b32 v11, 0xffff0000, v137
    v_fma_f32 v8, v8, v97, v96
    v_fma_f32 v9, v9, v97, v96
    v_fma_f32 v10, v10, v97, v96
    v_fma_f32 v11, v11, v97, v96
    v_mul_f32 v12, 0xbfb8aa3b, v8
    v_mul_f32 v15, 0xbfb8aa3b, v9
    v_mul_f32 v4, 0xbfb8aa3b, v10
    v_mul_f32 v5, 0xbfb8aa3b, v11
    v_exp_f32 v12, v12
    v_exp_f32 v15, v15
    v_exp_f32 v4, v4
    v_exp_f32 v5, v5
    v_add_f32 v12, 1.0, v12
    v_add_f32 v15, 1.0, v15
    v_add_f32 v4, 1.0, v4
    v_add_f32 v5, 1.0, v5
    v_rcp_f32 v12, v12
    v_rcp_f32 v15, v15
    v_rcp_f32 v4, v4
    v_rcp_f32 v5, v5
    v_mul_f32 v8, v8, v12
    v_mul_f32 v9, v9, v15
    v_mul_f32 v10, v10, v4
    v_mul_f32 v11, v11, v5
    v_cvt_pk_bf16_f32 v158, v8, v9
    v_cvt_pk_bf16_f32 v159, v10, v11
    v_lshlrev_b32 v8, 16, v138
    v_and_b32 v9, 0xffff0000, v138
    v_lshlrev_b32 v10, 16, v139
    v_and_b32 v11, 0xffff0000, v139
    v_fma_f32 v8, v8, v97, v96
    v_fma_f32 v9, v9, v97, v96
    v_fma_f32 v10, v10, v97, v96
    v_fma_f32 v11, v11, v97, v96
    v_mul_f32 v12, 0xbfb8aa3b, v8
    v_mul_f32 v15, 0xbfb8aa3b, v9
    v_mul_f32 v4, 0xbfb8aa3b, v10
    v_mul_f32 v5, 0xbfb8aa3b, v11
    v_exp_f32 v12, v12
    v_exp_f32 v15, v15
    v_exp_f32 v4, v4
    v_exp_f32 v5, v5
    v_add_f32 v12, 1.0, v12
    v_add_f32 v15, 1.0, v15
    v_add_f32 v4, 1.0, v4
    v_add_f32 v5, 1.0, v5
    v_rcp_f32 v12, v12
    v_rcp_f32 v15, v15
    v_rcp_f32 v4, v4
    v_rcp_f32 v5, v5
    v_mul_f32 v8, v8, v12
    v_mul_f32 v9, v9, v15
    v_mul_f32 v10, v10, v4
    v_mul_f32 v11, v11, v5
    v_cvt_pk_bf16_f32 v160, v8, v9
    v_cvt_pk_bf16_f32 v161, v10, v11
    v_lshlrev_b32 v8, 16, v140
    v_and_b32 v9, 0xffff0000, v140
    v_lshlrev_b32 v10, 16, v141
    v_and_b32 v11, 0xffff0000, v141
    v_fma_f32 v8, v8, v97, v96
    v_fma_f32 v9, v9, v97, v96
    v_fma_f32 v10, v10, v97, v96
    v_fma_f32 v11, v11, v97, v96
    v_mul_f32 v12, 0xbfb8aa3b, v8
    v_mul_f32 v15, 0xbfb8aa3b, v9
    v_mul_f32 v4, 0xbfb8aa3b, v10
    v_mul_f32 v5, 0xbfb8aa3b, v11
    v_exp_f32 v12, v12
    v_exp_f32 v15, v15
    v_exp_f32 v4, v4
    v_exp_f32 v5, v5
    v_add_f32 v12, 1.0, v12
    v_add_f32 v15, 1.0, v15
    v_add_f32 v4, 1.0, v4
    v_add_f32 v5, 1.0, v5
    v_rcp_f32 v12, v12
    v_rcp_f32 v15, v15
    v_rcp_f32 v4, v4
    v_rcp_f32 v5, v5
    v_mul_f32 v8, v8, v12
    v_mul_f32 v9, v9, v15
    v_mul_f32 v10, v10, v4
    v_mul_f32 v11, v11, v5
    v_cvt_pk_bf16_f32 v162, v8, v9
    v_cvt_pk_bf16_f32 v163, v10, v11
    v_lshlrev_b32 v8, 16, v142
    v_and_b32 v9, 0xffff0000, v142
    v_lshlrev_b32 v10, 16, v143
    v_and_b32 v11, 0xffff0000, v143
    v_fma_f32 v8, v8, v97, v96
    v_fma_f32 v9, v9, v97, v96
    v_fma_f32 v10, v10, v97, v96
    v_fma_f32 v11, v11, v97, v96
    v_mul_f32 v12, 0xbfb8aa3b, v8
    v_mul_f32 v15, 0xbfb8aa3b, v9
    v_mul_f32 v4, 0xbfb8aa3b, v10
    v_mul_f32 v5, 0xbfb8aa3b, v11
    v_exp_f32 v12, v12
    v_exp_f32 v15, v15
    v_exp_f32 v4, v4
    v_exp_f32 v5, v5
    v_add_f32 v12, 1.0, v12
    v_add_f32 v15, 1.0, v15
    v_add_f32 v4, 1.0, v4
    v_add_f32 v5, 1.0, v5
    v_rcp_f32 v12, v12
    v_rcp_f32 v15, v15
    v_rcp_f32 v4, v4
    v_rcp_f32 v5, v5
    v_mul_f32 v8, v8, v12
    v_mul_f32 v9, v9, v15
    v_mul_f32 v10, v10, v4
    v_mul_f32 v11, v11, v5
    v_cvt_pk_bf16_f32 v164, v8, v9
    v_cvt_pk_bf16_f32 v165, v10, v11
L_p3_gback:
    s_mov_b32 s54, 0
    s_waitcnt vmcnt(0)
    s_mov_b64 exec, 1
    buffer_store_dword v89, off, s[24:27], s51 sc1
    ds_add_u32 v88, v89
    s_mov_b64 exec, -1
    ds_read_b32 v13, v14
    s_waitcnt lgkmcnt(0)
    v_readfirstlane_b32 s40, v13
    s_add_u32 s8, s46, 16777216
    s_addc_u32 s9, s47, 0
    s_mov_b32 s10, 4194304
    s_mov_b32 s11, 0x20000
    s_mov_b32 s16, s52
    s_mov_b32 s17, s53
    s_mov_b32 s18, 4194304
    s_mov_b32 s19, 0x20000
    s_mov_b32 s59, 7
    s_cmp_eq_u32 s40, 0
    s_cbranch_scc1 L_p3_first
L_p3_firstok:
    s_sub_u32 s40, s40, 1
    s_lshl_b32 s44, s40, 13
    s_add_u32 s44, s44, s62
    s_add_u32 s45, s44, 4096
    s_lshl_b32 s35, s40, 14
    v_add_u32 v30, s35, v2
    v_add_u32 v31, s35, v6
    s_cmp_eq_u32 s40, 3
    s_cselect_b32 s58, 66560, 0
    buffer_load_dwordx4 v[96:99], v7, s[8:11], s44 offen offset:0 sc1
    buffer_load_dwordx4 v[100:103], v7, s[8:11], s44 offen offset:1024 sc1
    buffer_load_dwordx4 v[104:107], v7, s[8:11], s44 offen offset:2048 sc1
    buffer_load_dwordx4 v[108:111], v7, s[8:11], s44 offen offset:3072 sc1
    buffer_load_dwordx4 v[112:115], v7, s[8:11], s45 offen offset:0 sc1
    buffer_load_dwordx4 v[116:119], v7, s[8:11], s45 offen offset:1024 sc1
    buffer_load_dwordx4 v[120:123], v7, s[8:11], s45 offen offset:2048 sc1
    s_cmp_lg_u32 s54, 0
    s_cbranch_scc1 L_p3_nz
    s_mov_b32 s54, 1
    v_mov_b32 v32, 0
    v_mov_b32 v33, 0
    v_mov_b32 v34, 0
    v_mov_b32 v35, 0
    v_mov_b32 v36, 0
    v_mov_b32 v37, 0
    v_mov_b32 v38, 0
    v_mov_b32 v39, 0
    v_mov_b32 v40, 0
    v_mov_b32 v41, 0
    v_mov_b32 v42, 0
    v_mov_b32 v43, 0
    v_mov_b32 v44, 0
    v_mov_b32 v45, 0
    v_mov_b32 v46, 0
    v_mov_b32 v47, 0
    v_mov_b32 v48, 0
    v_mov_b32 v49, 0
    v_mov_b32 v50, 0
    v_mov_b32 v51, 0
    v_mov_b32 v52, 0
    v_mov_b32 v53, 0
    v_mov_b32 v54, 0
    v_mov_b32 v55, 0
    v_mov_b32 v56, 0
    v_mov_b32 v57, 0
    v_mov_b32 v58, 0
    v_mov_b32 v59, 0
    v_mov_b32 v60, 0
    v_mov_b32 v61, 0
    v_mov_b32 v62, 0
    v_mov_b32 v63, 0
L_p3_nz:
    ds_read_b64_tr_b16 v[64:65], v30 offset:0
    ds_read_b64_tr_b16 v[66:67], v30 offset:1024
    ds_read_b64_tr_b16 v[68:69], v31 offset:0
    ds_read_b64_tr_b16 v[70:71], v31 offset:1024
    ds_read_b64_tr_b16 v[72:73], v30 offset:2048
    ds_read_b64_tr_b16 v[74:75], v30 offset:3072
    ds_read_b64_tr_b16 v[76:77], v31 offset:2048
    ds_read_b64_tr_b16 v[78:79], v31 offset:3072
    ds_read_b64_tr_b16 v[80:81], v30 offset:4096
    ds_read_b64_tr_b16 v[82:83], v30 offset:5120
    ds_read_b64_tr_b16 v[84:85], v31 offset:4096
    ds_read_b64_tr_b16 v[86:87], v31 offset:5120
    s_mov_b32 s41, s44
    s_mov_b32 s42, s45
    s_mov_b32 s57, s58
    v_mov_b32 v10, v30
    v_mov_b32 v11, v31
    v_add_u32 v14, 4, v14
    .p2align 5
L_p3_grp:
    ds_read_b32 v13, v14
    s_waitcnt vmcnt(6) lgkmcnt(9)
    v_mfma_f32_32x32x16_bf16 v[32:47], v[64:67], v[96:99], v[32:47]
    ds_read_b64_tr_b16 v[88:89], v10 offset:6144
    ds_read_b64_tr_b16 v[90:91], v10 offset:7168
    buffer_load_dwordx4 v[124:127], v7, s[8:11], s42 offen offset:3072 sc1
    v_mfma_f32_32x32x16_bf16 v[48:63], v[68:71], v[96:99], v[48:63]
    ds_read_b64_tr_b16 v[92:93], v11 offset:6144
    ds_read_b64_tr_b16 v[94:95], v11 offset:7168
    s_waitcnt vmcnt(6) lgkmcnt(4)
    v_readfirstlane_b32 s40, v13
    v_mfma_f32_32x32x16_bf16 v[32:47], v[72:75], v[100:103], v[32:47]
    ds_read_b64_tr_b16 v[64:65], v10 offset:8192
    ds_read_b64_tr_b16 v[66:67], v10 offset:9216
    v_mfma_f32_32x32x16_bf16 v[48:63], v[76:79], v[100:103], v[48:63]
    ds_read_b64_tr_b16 v[68:69], v11 offset:8192
    ds_read_b64_tr_b16 v[70:71], v11 offset:9216
    s_cmp_eq_u32 s59, 0
    s_cselect_b32 s40, 0, s40
    s_cmp_eq_u32 s40, 0
    s_cbranch_scc1 L_p3_nopf
    s_sub_u32 s40, s40, 1
    s_lshl_b32 s44, s40, 13
    s_add_u32 s44, s44, s62
    s_add_u32 s45, s44, 4096
    s_lshl_b32 s35, s40, 14
    v_add_u32 v30, s35, v2
    v_add_u32 v31, s35, v6
    s_cmp_eq_u32 s40, 3
    s_cselect_b32 s58, 66560, 0
    buffer_load_dwordx4 v[96:99], v7, s[8:11], s44 offen offset:0 sc1
    s_waitcnt vmcnt(6) lgkmcnt(8)
    v_mfma_f32_32x32x16_bf16 v[32:47], v[80:83], v[104:107], v[32:47]
    ds_read_b64_tr_b16 v[72:73], v10 offset:10240
    ds_read_b64_tr_b16 v[74:75], v10 offset:11264
    buffer_load_dwordx4 v[100:103], v7, s[8:11], s44 offen offset:1024 sc1
    v_mfma_f32_32x32x16_bf16 v[48:63], v[84:87], v[104:107], v[48:63]
    ds_read_b64_tr_b16 v[76:77], v11 offset:10240
    ds_read_b64_tr_b16 v[78:79], v11 offset:11264
    s_waitcnt vmcnt(6) lgkmcnt(8)
    v_mfma_f32_32x32x16_bf16 v[32:47], v[88:91], v[108:111], v[32:47]
    ds_read_b64_tr_b16 v[80:81], v10 offset:12288
    ds_read_b64_tr_b16 v[82:83], v10 offset:13312
    buffer_load_dwordx4 v[104:107], v7, s[8:11], s44 offen offset:2048 sc1
    v_mfma_f32_32x32x16_bf16 v[48:63], v[92:95], v[108:111], v[48:63]
    ds_read_b64_tr_b16 v[84:85], v11 offset:12288
    ds_read_b64_tr_b16 v[86:87], v11 offset:13312
    s_waitcnt vmcnt(6) lgkmcnt(8)
    v_add_u32 v4, s57, v10
    v_add_u32 v5, s57, v11
    v_mfma_f32_32x32x16_bf16 v[32:47], v[64:67], v[112:115], v[32:47]
    ds_read_b64_tr_b16 v[88:89], v10 offset:14336
    ds_read_b64_tr_b16 v[90:91], v4 offset:15360
    buffer_load_dwordx4 v[108:111], v7, s[8:11], s44 offen offset:3072 sc1
    v_mfma_f32_32x32x16_bf16 v[48:63], v[68:71], v[112:115], v[48:63]
    ds_read_b64_tr_b16 v[92:93], v11 offset:14336
    ds_read_b64_tr_b16 v[94:95], v5 offset:15360
    s_waitcnt vmcnt(6) lgkmcnt(8)
    v_mfma_f32_32x32x16_bf16 v[32:47], v[72:75], v[116:119], v[32:47]
    ds_read_b64_tr_b16 v[64:65], v30 offset:0
    ds_read_b64_tr_b16 v[66:67], v30 offset:1024
    buffer_load_dwordx4 v[112:115], v7, s[8:11], s45 offen offset:0 sc1
    v_mfma_f32_32x32x16_bf16 v[48:63], v[76:79], v[116:119], v[48:63]
    ds_read_b64_tr_b16 v[68:69], v31 offset:0
    ds_read_b64_tr_b16 v[70:71], v31 offset:1024
    s_waitcnt vmcnt(6) lgkmcnt(8)
    v_mfma_f32_32x32x16_bf16 v[32:47], v[80:83], v[120:123], v[32:47]
    ds_read_b64_tr_b16 v[72:73], v30 offset:2048
    ds_read_b64_tr_b16 v[74:75], v30 offset:3072
    buffer_load_dwordx4 v[116:119], v7, s[8:11], s45 offen offset:1024 sc1
    v_mfma_f32_32x32x16_bf16 v[48:63], v[84:87], v[120:123], v[48:63]
    ds_read_b64_tr_b16 v[76:77], v31 offset:2048
    ds_read_b64_tr_b16 v[78:79], v31 offset:3072
    s_waitcnt vmcnt(6) lgkmcnt(8)
    v_mfma_f32_32x32x16_bf16 v[32:47], v[88:91], v[124:127], v[32:47]
    ds_read_b64_tr_b16 v[80:81], v30 offset:4096
    ds_read_b64_tr_b16 v[82:83], v30 offset:5120
    buffer_load_dwordx4 v[120:123], v7, s[8:11], s45 offen offset:2048 sc1
    v_mfma_f32_32x32x16_bf16 v[48:63], v[92:95], v[124:127], v[48:63]
    ds_read_b64_tr_b16 v[84:85], v31 offset:4096
    ds_read_b64_tr_b16 v[86:87], v31 offset:5120
    s_mov_b32 s41, s44
    s_mov_b32 s42, s45
    s_mov_b32 s57, s58
    v_mov_b32 v10, v30
    v_mov_b32 v11, v31
    v_add_u32 v14, 4, v14
    s_sub_u32 s59, s59, 1
    s_branch L_p3_grp
L_p3_nopf:
    s_waitcnt vmcnt(5) lgkmcnt(8)
    v_mfma_f32_32x32x16_bf16 v[32:47], v[80:83], v[104:107], v[32:47]
    ds_read_b64_tr_b16 v[72:73], v10 offset:10240
    ds_read_b64_tr_b16 v[74:75], v10 offset:11264
    v_mfma_f32_32x32x16_bf16 v[48:63], v[84:87], v[104:107], v[48:63]
    ds_read_b64_tr_b16 v[76:77], v11 offset:10240
    ds_read_b64_tr_b16 v[78:79], v11 offset:11264
    s_waitcnt vmcnt(4) lgkmcnt(8)
    v_mfma_f32_32x32x16_bf16 v[32:47], v[88:91], v[108:111], v[32:47]
    ds_read_b64_tr_b16 v[80:81], v10 offset:12288
    ds_read_b64_tr_b16 v[82:83], v10 offset:13312
    v_mfma_f32_32x32x16_bf16 v[48:63], v[92:95], v[108:111], v[48:63]
    ds_read_b64_tr_b16 v[84:85], v11 offset:12288
    ds_read_b64_tr_b16 v[86:87], v11 offset:13312
    s_waitcnt vmcnt(3) lgkmcnt(8)
    v_add_u32 v4, s57, v10
    v_add_u32 v5, s57, v11
    v_mfma_f32_32x32x16_bf16 v[32:47], v[64:67], v[112:115], v[32:47]
    ds_read_b64_tr_b16 v[88:89], v10 offset:14336
    ds_read_b64_tr_b16 v[90:91], v4 offset:15360
    v_mfma_f32_32x32x16_bf16 v[48:63], v[68:71], v[112:115], v[48:63]
    ds_read_b64_tr_b16 v[92:93], v11 offset:14336
    ds_read_b64_tr_b16 v[94:95], v5 offset:15360
    s_waitcnt vmcnt(2) lgkmcnt(8)
    v_mfma_f32_32x32x16_bf16 v[32:47], v[72:75], v[116:119], v[32:47]
    v_mfma_f32_32x32x16_bf16 v[48:63], v[76:79], v[116:119], v[48:63]
    s_waitcnt vmcnt(1) lgkmcnt(4)
    v_mfma_f32_32x32x16_bf16 v[32:47], v[80:83], v[120:123], v[32:47]
    v_mfma_f32_32x32x16_bf16 v[48:63], v[84:87], v[120:123], v[48:63]
    s_waitcnt vmcnt(0) lgkmcnt(0)
    v_mfma_f32_32x32x16_bf16 v[32:47], v[88:91], v[124:127], v[32:47]
    v_mfma_f32_32x32x16_bf16 v[48:63], v[92:95], v[124:127], v[48:63]
    s_cmp_eq_u32 s59, 0
    s_cbranch_scc1 L_p3_fin
    s_sub_u32 s59, s59, 1
    s_branch L_p3_first
L_p3_fin:
    v_lshlrev_b32 v64, 16, v128
    v_and_b32 v65, 0xffff0000, v128
    v_lshlrev_b32 v72, 16, v150
    v_and_b32 v73, 0xffff0000, v150
    v_lshlrev_b32 v66, 16, v129
    v_and_b32 v67, 0xffff0000, v129
    v_lshlrev_b32 v74, 16, v151
    v_and_b32 v75, 0xffff0000, v151
    v_lshlrev_b32 v68, 16, v130
    v_and_b32 v69, 0xffff0000, v130
    v_lshlrev_b32 v76, 16, v152
    v_and_b32 v77, 0xffff0000, v152
    v_lshlrev_b32 v70, 16, v131
    v_and_b32 v71, 0xffff0000, v131
    v_lshlrev_b32 v78, 16, v153
    v_and_b32 v79, 0xffff0000, v153
    v_fma_f32 v32, v32, v72, v64
    v_fma_f32 v33, v33, v73, v65
    v_cvt_pk_bf16_f32 v8, v32, v33
    v_fma_f32 v34, v34, v74, v66
    v_fma_f32 v35, v35, v75, v67
    v_cvt_pk_bf16_f32 v9, v34, v35
    v_fma_f32 v36, v36, v76, v68
    v_fma_f32 v37, v37, v77, v69
    v_cvt_pk_bf16_f32 v10, v36, v37
    v_fma_f32 v38, v38, v78, v70
    v_fma_f32 v39, v39, v79, v71
    v_cvt_pk_bf16_f32 v11, v38, v39
    buffer_store_dwordx4 v[8:11], v3, s[16:19], 0 offen offset:0
    v_lshlrev_b32 v80, 16, v132
    v_and_b32 v81, 0xffff0000, v132
    v_lshlrev_b32 v82, 16, v154
    v_and_b32 v83, 0xffff0000, v154
    v_fma_f32 v40, v40, v82, v80
    v_fma_f32 v41, v41, v83, v81
    v_cvt_pk_bf16_f32 v12, v40, v41
    v_lshlrev_b32 v80, 16, v133
    v_and_b32 v81, 0xffff0000, v133
    v_lshlrev_b32 v82, 16, v155
    v_and_b32 v83, 0xffff0000, v155
    v_fma_f32 v42, v42, v82, v80
    v_fma_f32 v43, v43, v83, v81
    v_cvt_pk_bf16_f32 v13, v42, v43
    v_lshlrev_b32 v80, 16, v134
    v_and_b32 v81, 0xffff0000, v134
    v_lshlrev_b32 v82, 16, v156
    v_and_b32 v83, 0xffff0000, v156
    v_fma_f32 v44, v44, v82, v80
    v_fma_f32 v45, v45, v83, v81
    v_cvt_pk_bf16_f32 v14, v44, v45
    v_lshlrev_b32 v80, 16, v135
    v_and_b32 v81, 0xffff0000, v135
    v_lshlrev_b32 v82, 16, v157
    v_and_b32 v83, 0xffff0000, v157
    v_fma_f32 v46, v46, v82, v80
    v_fma_f32 v47, v47, v83, v81
    v_cvt_pk_bf16_f32 v15, v46, v47
    buffer_store_dwordx4 v[12:15], v3, s[16:19], 0 offen offset:32
    v_lshlrev_b32 v80, 16, v136
    v_and_b32 v81, 0xffff0000, v136
    v_lshlrev_b32 v82, 16, v158
    v_and_b32 v83, 0xffff0000, v158
    v_fma_f32 v48, v48, v82, v80
    v_fma_f32 v49, v49, v83, v81
    v_cvt_pk_bf16_f32 v16, v48, v49
    v_lshlrev_b32 v80, 16, v137
    v_and_b32 v81, 0xffff0000, v137
    v_lshlrev_b32 v82, 16, v159
    v_and_b32 v83, 0xffff0000, v159
    v_fma_f32 v50, v50, v82, v80
    v_fma_f32 v51, v51, v83, v81
    v_cvt_pk_bf16_f32 v17, v50, v51
    v_lshlrev_b32 v80, 16, v138
    v_and_b32 v81, 0xffff0000, v138
    v_lshlrev_b32 v82, 16, v160
    v_and_b32 v83, 0xffff0000, v160
    v_fma_f32 v52, v52, v82, v80
    v_fma_f32 v53, v53, v83, v81
    v_cvt_pk_bf16_f32 v18, v52, v53
    v_lshlrev_b32 v80, 16, v139
    v_and_b32 v81, 0xffff0000, v139
    v_lshlrev_b32 v82, 16, v161
    v_and_b32 v83, 0xffff0000, v161
    v_fma_f32 v54, v54, v82, v80
    v_fma_f32 v55, v55, v83, v81
    v_cvt_pk_bf16_f32 v19, v54, v55
    buffer_store_dwordx4 v[16:19], v3, s[16:19], 0 offen offset:64
    v_lshlrev_b32 v80, 16, v140
    v_and_b32 v81, 0xffff0000, v140
    v_lshlrev_b32 v82, 16, v162
    v_and_b32 v83, 0xffff0000, v162
    v_fma_f32 v56, v56, v82, v80
    v_fma_f32 v57, v57, v83, v81
    v_cvt_pk_bf16_f32 v20, v56, v57
    v_lshlrev_b32 v80, 16, v141
    v_and_b32 v81, 0xffff0000, v141
    v_lshlrev_b32 v82, 16, v163
    v_and_b32 v83, 0xffff0000, v163
    v_fma_f32 v58, v58, v82, v80
    v_fma_f32 v59, v59, v83, v81
    v_cvt_pk_bf16_f32 v21, v58, v59
    v_lshlrev_b32 v80, 16, v142
    v_and_b32 v81, 0xffff0000, v142
    v_lshlrev_b32 v82, 16, v164
    v_and_b32 v83, 0xffff0000, v164
    v_fma_f32 v60, v60, v82, v80
    v_fma_f32 v61, v61, v83, v81
    v_cvt_pk_bf16_f32 v22, v60, v61
    v_lshlrev_b32 v80, 16, v143
    v_and_b32 v81, 0xffff0000, v143
    v_lshlrev_b32 v82, 16, v165
    v_and_b32 v83, 0xffff0000, v165
    v_fma_f32 v62, v62, v82, v80
    v_fma_f32 v63, v63, v83, v81
    v_cvt_pk_bf16_f32 v23, v62, v63
    buffer_store_dwordx4 v[20:23], v3, s[16:19], 0 offen offset:96
L_done:
    s_endpgm
L_h_slow:
    s_mov_b32 s55, 1
    s_mov_b32 s61, 262144
L_rt_30:
    s_waitcnt vmcnt(0)
    v_cmp_eq_u32 vcc, 0, v146
    s_nop 1
    s_cmp_eq_u32 vcc_lo, 0
    s_cbranch_scc1 L_rte_31
    s_sleep 8
    v_and_b32 v4, 15, v1
    v_lshlrev_b32 v4, 2, v4
    s_mov_b32 s21, 262144
    buffer_load_dword v146, v4, s[24:27], s21 offen sc1
    s_sub_u32 s61, s61, 1
    s_cmp_lg_u32 s61, 0
    s_cbranch_scc1 L_rt_30
    s_waitcnt vmcnt(0)
L_rte_31:
    s_mov_b32 s61, 262144
L_rt_32:
    s_waitcnt vmcnt(0)
    v_min_u32 v4, v144, v145
    v_cmp_eq_u32 vcc, 0, v4
    s_nop 1
    s_cmp_eq_u64 vcc, 0
    s_cbranch_scc1 L_rte_33
    s_sleep 8
    v_lshlrev_b32 v4, 3, v148
    s_mov_b32 s21, 270336
    buffer_load_dwordx2 v[144:145], v4, s[24:27], s21 offen sc1
    s_sub_u32 s61, s61, 1
    s_cmp_lg_u32 s61, 0
    s_cbranch_scc1 L_rt_32
    s_waitcnt vmcnt(0)
L_rte_33:
    v_add_u32 v4, -1, v146
    v_lshrrev_b32 v4, 5, v4
    v_lshrrev_b32 v5, 5, v148
    v_cmp_eq_u32 vcc, v4, v5
    s_nop 1
    s_and_b32 s56, vcc_lo, 0xff
    s_cbranch_scc0 L_h_back
    v_mov_b32 v90, 0
    v_mov_b32 v6, 0x7ff0000
    v_add_u32 v5, 1, v148
    v_readlane_b32 s40, v146, 0
    v_readlane_b32 s41, v146, 8
    v_mov_b32 v4, 0
    v_mov_b32 v91, s41
    v_cmp_eq_u32 vcc, s40, v5
    s_nop 1
    v_cndmask_b32 v6, v6, v4, vcc
    v_cndmask_b32 v90, v90, v91, vcc
    v_readlane_b32 s40, v146, 1
    v_readlane_b32 s41, v146, 9
    v_mov_b32 v4, 4096
    v_mov_b32 v91, s41
    v_cmp_eq_u32 vcc, s40, v5
    s_nop 1
    v_cndmask_b32 v6, v6, v4, vcc
    v_cndmask_b32 v90, v90, v91, vcc
    v_readlane_b32 s40, v146, 2
    v_readlane_b32 s41, v146, 10
    v_mov_b32 v4, 8192
    v_mov_b32 v91, s41
    v_cmp_eq_u32 vcc, s40, v5
    s_nop 1
    v_cndmask_b32 v6, v6, v4, vcc
    v_cndmask_b32 v90, v90, v91, vcc
    v_readlane_b32 s40, v146, 3
    v_readlane_b32 s41, v146, 11
    v_mov_b32 v4, 12288
    v_mov_b32 v91, s41
    v_cmp_eq_u32 vcc, s40, v5
    s_nop 1
    v_cndmask_b32 v6, v6, v4, vcc
    v_cndmask_b32 v90, v90, v91, vcc
    v_readlane_b32 s40, v146, 4
    v_readlane_b32 s41, v146, 12
    v_mov_b32 v4, 16384
    v_mov_b32 v91, s41
    v_cmp_eq_u32 vcc, s40, v5
    s_nop 1
    v_cndmask_b32 v6, v6, v4, vcc
    v_cndmask_b32 v90, v90, v91, vcc
    v_readlane_b32 s40, v146, 5
    v_readlane_b32 s41, v146, 13
    v_mov_b32 v4, 20480
    v_mov_b32 v91, s41
    v_cmp_eq_u32 vcc, s40, v5
    s_nop 1
    v_cndmask_b32 v6, v6, v4, vcc
    v_cndmask_b32 v90, v90, v91, vcc
    v_readlane_b32 s40, v146, 6
    v_readlane_b32 s41, v146, 14
    v_mov_b32 v4, 24576
    v_mov_b32 v91, s41
    v_cmp_eq_u32 vcc, s40, v5
    s_nop 1
    v_cndmask_b32 v6, v6, v4, vcc
    v_cndmask_b32 v90, v90, v91, vcc
    v_readlane_b32 s40, v146, 7
    v_readlane_b32 s41, v146, 15
    v_mov_b32 v4, 28672
    v_mov_b32 v91, s41
    v_cmp_eq_u32 vcc, s40, v5
    s_nop 1
    v_cndmask_b32 v6, v6, v4, vcc
    v_cndmask_b32 v90, v90, v91, vcc
    v_lshl_add_u32 v6, v149, 1, v6
    v_mov_b32 v4, 64524
    s_mov_b32 s61, 1048576
L_lw_34:
    ds_read_b32 v5, v4
    s_waitcnt lgkmcnt(0)
    v_cmp_gt_u32 vcc, 1, v5
    s_cbranch_vccz L_lwe_35
    s_sleep 2
    s_sub_u32 s61, s61, 1
    s_cmp_lg_u32 s61, 0
    s_cbranch_scc1 L_lw_34
L_lwe_35:
    v_mov_b32 v91, v6
    s_mov_b32 s21, 229376
    buffer_load_dwordx4 v[64:67], v91, s[24:27], s21 offen offset:0 sc1
    buffer_load_dwordx4 v[68:71], v91, s[24:27], s21 offen offset:16 sc1
    buffer_load_dwordx4 v[72:75], v91, s[24:27], s21 offen offset:64 sc1
    buffer_load_dwordx4 v[76:79], v91, s[24:27], s21 offen offset:80 sc1
    buffer_load_dwordx4 v[24:27], v91, s[24:27], s21 offen offset:128 sc1
    buffer_load_dwordx4 v[28:31], v91, s[24:27], s21 offen offset:144 sc1
    buffer_load_dwordx4 v[32:35], v91, s[24:27], s21 offen offset:192 sc1
    buffer_load_dwordx4 v[36:39], v91, s[24:27], s21 offen offset:208 sc1
    s_branch L_h_back
L_as_17:
    s_mov_b32 s61, 1048576
L_lw_36:
    ds_read_b32 v126, v124
    s_waitcnt lgkmcnt(0)
    v_cmp_gt_u32 vcc, s50, v126
    s_cbranch_vccz L_lwe_37
    s_sleep 1
    s_sub_u32 s61, s61, 1
    s_cmp_lg_u32 s61, 0
    s_cbranch_scc1 L_lw_36
L_lwe_37:
    s_branch L_ar_18
L_as_20:
    s_mov_b32 s61, 1048576
L_lw_38:
    ds_read_b32 v126, v124
    s_waitcnt lgkmcnt(0)
    v_cmp_gt_u32 vcc, s50, v126
    s_cbranch_vccz L_lwe_39
    s_sleep 1
    s_sub_u32 s61, s61, 1
    s_cmp_lg_u32 s61, 0
    s_cbranch_scc1 L_lw_38
L_lwe_39:
    s_branch L_ar_21
L_as_23:
    s_mov_b32 s61, 1048576
L_lw_40:
    ds_read_b32 v126, v124
    s_waitcnt lgkmcnt(0)
    v_cmp_gt_u32 vcc, s50, v126
    s_cbranch_vccz L_lwe_41
    s_sleep 1
    s_sub_u32 s61, s61, 1
    s_cmp_lg_u32 s61, 0
    s_cbranch_scc1 L_lw_40
L_lwe_41:
    s_branch L_ar_24
L_as_27:
    s_mov_b32 s61, 1048576
L_lw_42:
    ds_read_b32 v126, v124
    s_waitcnt lgkmcnt(0)
    v_cmp_gt_u32 vcc, s50, v126
    s_cbranch_vccz L_lwe_43
    s_sleep 1
    s_sub_u32 s61, s61, 1
    s_cmp_lg_u32 s61, 0
    s_cbranch_scc1 L_lw_42
L_lwe_43:
    s_branch L_ar_28
L_att_slow:
    v_mov_b32 v6, 0xff800000
    v_mov_b32 v127, 0
    s_mov_b32 s20, 0
    v_mov_b32 v48, 0
    v_mov_b32 v49, 0
    v_mov_b32 v50, 0
    v_mov_b32 v51, 0
    v_mov_b32 v52, 0
    v_mov_b32 v53, 0
    v_mov_b32 v54, 0
    v_mov_b32 v55, 0
    v_mov_b32 v56, 0
    v_mov_b32 v57, 0
    v_mov_b32 v58, 0
    v_mov_b32 v59, 0
    v_mov_b32 v60, 0
    v_mov_b32 v61, 0
    v_mov_b32 v62, 0
    v_mov_b32 v63, 0
L_att_slow_loop:
    s_waitcnt vmcnt(0)
    buffer_load_dwordx4 v[92:95], v7, s[8:11], s20 offen sc1
    buffer_load_dwordx4 v[96:99], v7, s[8:11], s20 offen offset:1024 sc1
    buffer_load_dwordx4 v[108:111], v7, s[8:11], s20 offen offset:2048 sc1
    buffer_load_dwordx4 v[112:115], v7, s[8:11], s20 offen offset:3072 sc1
    s_waitcnt vmcnt(0)
    v_mfma_f32_32x32x16_bf16 v[16:31], v[92:95], v[8:11], 0
    v_mfma_f32_32x32x16_bf16 v[16:31], v[96:99], v[12:15], v[16:31]
    s_nop 15
    s_nop 3
    v_max3_f32 v4, v16, v17, v6
    v_max3_f32 v4, v4, v18, v19
    v_max3_f32 v4, v4, v20, v21
    v_max3_f32 v4, v4, v22, v23
    v_max3_f32 v4, v4, v24, v25
    v_max3_f32 v4, v4, v26, v27
    v_max3_f32 v4, v4, v28, v29
    v_max3_f32 v4, v4, v30, v31
    v_mov_b32 v5, v4
    s_nop 1
    v_permlane32_swap_b32 v4, v5
    s_nop 1
    v_max_f32 v4, v4, v5
    v_sub_f32 v5, v6, v4
    v_exp_f32 v5, v5
    v_mov_b32 v6, v4
    v_mul_f32 v127, v127, v5
    v_mul_f32 v48, v48, v5
    v_sub_f32 v16, v16, v4
    v_exp_f32 v16, v16
    v_mul_f32 v49, v49, v5
    v_sub_f32 v17, v17, v4
    v_exp_f32 v17, v17
    v_mul_f32 v50, v50, v5
    v_sub_f32 v18, v18, v4
    v_exp_f32 v18, v18
    v_mul_f32 v51, v51, v5
    v_sub_f32 v19, v19, v4
    v_exp_f32 v19, v19
    v_mul_f32 v52, v52, v5
    v_sub_f32 v20, v20, v4
    v_exp_f32 v20, v20
    v_mul_f32 v53, v53, v5
    v_sub_f32 v21, v21, v4
    v_exp_f32 v21, v21
    v_mul_f32 v54, v54, v5
    v_sub_f32 v22, v22, v4
    v_exp_f32 v22, v22
    v_mul_f32 v55, v55, v5
    v_sub_f32 v23, v23, v4
    v_exp_f32 v23, v23
    v_mul_f32 v56, v56, v5
    v_sub_f32 v24, v24, v4
    v_exp_f32 v24, v24
    v_mul_f32 v57, v57, v5
    v_sub_f32 v25, v25, v4
    v_exp_f32 v25, v25
    v_mul_f32 v58, v58, v5
    v_sub_f32 v26, v26, v4
    v_exp_f32 v26, v26
    v_mul_f32 v59, v59, v5
    v_sub_f32 v27, v27, v4
    v_exp_f32 v27, v27
    v_mul_f32 v60, v60, v5
    v_sub_f32 v28, v28, v4
    v_exp_f32 v28, v28
    v_mul_f32 v61, v61, v5
    v_sub_f32 v29, v29, v4
    v_exp_f32 v29, v29
    v_mul_f32 v62, v62, v5
    v_sub_f32 v30, v30, v4
    v_exp_f32 v30, v30
    v_mul_f32 v63, v63, v5
    v_sub_f32 v31, v31, v4
    v_exp_f32 v31, v31
    s_nop 0
    v_and_b32 v16, 0xffff0000, v16
    v_add_f32 v127, v127, v16
    v_and_b32 v17, 0xffff0000, v17
    v_add_f32 v127, v127, v17
    v_and_b32 v18, 0xffff0000, v18
    v_add_f32 v127, v127, v18
    v_and_b32 v19, 0xffff0000, v19
    v_add_f32 v127, v127, v19
    v_and_b32 v20, 0xffff0000, v20
    v_add_f32 v127, v127, v20
    v_and_b32 v21, 0xffff0000, v21
    v_add_f32 v127, v127, v21
    v_and_b32 v22, 0xffff0000, v22
    v_add_f32 v127, v127, v22
    v_and_b32 v23, 0xffff0000, v23
    v_add_f32 v127, v127, v23
    v_and_b32 v24, 0xffff0000, v24
    v_add_f32 v127, v127, v24
    v_and_b32 v25, 0xffff0000, v25
    v_add_f32 v127, v127, v25
    v_and_b32 v26, 0xffff0000, v26
    v_add_f32 v127, v127, v26
    v_and_b32 v27, 0xffff0000, v27
    v_add_f32 v127, v127, v27
    v_and_b32 v28, 0xffff0000, v28
    v_add_f32 v127, v127, v28
    v_and_b32 v29, 0xffff0000, v29
    v_add_f32 v127, v127, v29
    v_and_b32 v30, 0xffff0000, v30
    v_add_f32 v127, v127, v30
    v_and_b32 v31, 0xffff0000, v31
    v_add_f32 v127, v127, v31
    v_smfmac_f32_32x32x32_bf16 v[48:63], v[108:111], v[16:23], v88
    v_smfmac_f32_32x32x32_bf16 v[48:63], v[112:115], v[24:31], v88
    s_add_u32 s20, s20, 4096
    s_cmp_lt_u32 s20, 262144
    s_nop 15
    s_nop 3
    s_cbranch_scc1 L_att_slow_loop
    v_mov_b32 v4, v127
    v_mov_b32 v5, v127
    s_nop 1
    v_permlane32_swap_b32 v4, v5
    s_nop 1
    v_add_f32 v4, v4, v5
    s_cmp_eq_u32 s56, 0
    s_cbranch_scc1 L_att_fin
    s_mov_b32 s21, 229376
    buffer_load_dwordx4 v[64:67], v91, s[24:27], s21 offen offset:0 sc1
    buffer_load_dwordx4 v[68:71], v91, s[24:27], s21 offen offset:16 sc1
    buffer_load_dwordx4 v[72:75], v91, s[24:27], s21 offen offset:64 sc1
    buffer_load_dwordx4 v[76:79], v91, s[24:27], s21 offen offset:80 sc1
    buffer_load_dwordx4 v[24:27], v91, s[24:27], s21 offen offset:128 sc1
    buffer_load_dwordx4 v[28:31], v91, s[24:27], s21 offen offset:144 sc1
    buffer_load_dwordx4 v[32:35], v91, s[24:27], s21 offen offset:192 sc1
    buffer_load_dwordx4 v[36:39], v91, s[24:27], s21 offen offset:208 sc1
    s_branch L_att_fin
L_p3_first:
    s_mov_b32 s61, 1048576
L_nz_44:
    ds_read_b32 v13, v14 offset:0
    s_waitcnt lgkmcnt(0)
    v_readfirstlane_b32 s40, v13
    s_nop 0
    s_cmp_lg_u32 s40, 0
    s_cbranch_scc1 L_nze_45
    s_sleep 1
    s_sub_u32 s61, s61, 1
    s_cmp_lg_u32 s61, 0
    s_cbranch_scc1 L_nz_44
    s_mov_b32 s40, 1
L_nze_45:
    s_branch L_p3_firstok
L_p3_gsel:
    s_cmp_lg_u32 s56, 0
    s_cbranch_scc1 L_p3_gsel2
    v_mul_f32 v96, v144, v145
    v_sub_f32 v96, 0, v96
    v_mov_b32 v97, v145
    v_lshlrev_b32 v8, 16, v128
    v_and_b32 v9, 0xffff0000, v128
    v_lshlrev_b32 v10, 16, v129
    v_and_b32 v11, 0xffff0000, v129
    v_fma_f32 v8, v8, v97, v96
    v_fma_f32 v9, v9, v97, v96
    v_fma_f32 v10, v10, v97, v96
    v_fma_f32 v11, v11, v97, v96
    v_mul_f32 v12, 0xbfb8aa3b, v8
    v_mul_f32 v15, 0xbfb8aa3b, v9
    v_mul_f32 v4, 0xbfb8aa3b, v10
    v_mul_f32 v5, 0xbfb8aa3b, v11
    v_exp_f32 v12, v12
    v_exp_f32 v15, v15
    v_exp_f32 v4, v4
    v_exp_f32 v5, v5
    v_add_f32 v12, 1.0, v12
    v_add_f32 v15, 1.0, v15
    v_add_f32 v4, 1.0, v4
    v_add_f32 v5, 1.0, v5
    v_rcp_f32 v12, v12
    v_rcp_f32 v15, v15
    v_rcp_f32 v4, v4
    v_rcp_f32 v5, v5
    v_mul_f32 v8, v8, v12
    v_mul_f32 v9, v9, v15
    v_mul_f32 v10, v10, v4
    v_mul_f32 v11, v11, v5
    v_cvt_pk_bf16_f32 v150, v8, v9
    v_cvt_pk_bf16_f32 v151, v10, v11
    v_lshlrev_b32 v8, 16, v130
    v_and_b32 v9, 0xffff0000, v130
    v_lshlrev_b32 v10, 16, v131
    v_and_b32 v11, 0xffff0000, v131
    v_fma_f32 v8, v8, v97, v96
    v_fma_f32 v9, v9, v97, v96
    v_fma_f32 v10, v10, v97, v96
    v_fma_f32 v11, v11, v97, v96
    v_mul_f32 v12, 0xbfb8aa3b, v8
    v_mul_f32 v15, 0xbfb8aa3b, v9
    v_mul_f32 v4, 0xbfb8aa3b, v10
    v_mul_f32 v5, 0xbfb8aa3b, v11
    v_exp_f32 v12, v12
    v_exp_f32 v15, v15
    v_exp_f32 v4, v4
    v_exp_f32 v5, v5
    v_add_f32 v12, 1.0, v12
    v_add_f32 v15, 1.0, v15
    v_add_f32 v4, 1.0, v4
    v_add_f32 v5, 1.0, v5
    v_rcp_f32 v12, v12
    v_rcp_f32 v15, v15
    v_rcp_f32 v4, v4
    v_rcp_f32 v5, v5
    v_mul_f32 v8, v8, v12
    v_mul_f32 v9, v9, v15
    v_mul_f32 v10, v10, v4
    v_mul_f32 v11, v11, v5
    v_cvt_pk_bf16_f32 v152, v8, v9
    v_cvt_pk_bf16_f32 v153, v10, v11
    v_lshlrev_b32 v8, 16, v132
    v_and_b32 v9, 0xffff0000, v132
    v_lshlrev_b32 v10, 16, v133
    v_and_b32 v11, 0xffff0000, v133
    v_fma_f32 v8, v8, v97, v96
    v_fma_f32 v9, v9, v97, v96
    v_fma_f32 v10, v10, v97, v96
    v_fma_f32 v11, v11, v97, v96
    v_mul_f32 v12, 0xbfb8aa3b, v8
    v_mul_f32 v15, 0xbfb8aa3b, v9
    v_mul_f32 v4, 0xbfb8aa3b, v10
    v_mul_f32 v5, 0xbfb8aa3b, v11
    v_exp_f32 v12, v12
    v_exp_f32 v15, v15
    v_exp_f32 v4, v4
    v_exp_f32 v5, v5
    v_add_f32 v12, 1.0, v12
    v_add_f32 v15, 1.0, v15
    v_add_f32 v4, 1.0, v4
    v_add_f32 v5, 1.0, v5
    v_rcp_f32 v12, v12
    v_rcp_f32 v15, v15
    v_rcp_f32 v4, v4
    v_rcp_f32 v5, v5
    v_mul_f32 v8, v8, v12
    v_mul_f32 v9, v9, v15
    v_mul_f32 v10, v10, v4
    v_mul_f32 v11, v11, v5
    v_cvt_pk_bf16_f32 v154, v8, v9
    v_cvt_pk_bf16_f32 v155, v10, v11
    v_lshlrev_b32 v8, 16, v134
    v_and_b32 v9, 0xffff0000, v134
    v_lshlrev_b32 v10, 16, v135
    v_and_b32 v11, 0xffff0000, v135
    v_fma_f32 v8, v8, v97, v96
    v_fma_f32 v9, v9, v97, v96
    v_fma_f32 v10, v10, v97, v96
    v_fma_f32 v11, v11, v97, v96
    v_mul_f32 v12, 0xbfb8aa3b, v8
    v_mul_f32 v15, 0xbfb8aa3b, v9
    v_mul_f32 v4, 0xbfb8aa3b, v10
    v_mul_f32 v5, 0xbfb8aa3b, v11
    v_exp_f32 v12, v12
    v_exp_f32 v15, v15
    v_exp_f32 v4, v4
    v_exp_f32 v5, v5
    v_add_f32 v12, 1.0, v12
    v_add_f32 v15, 1.0, v15
    v_add_f32 v4, 1.0, v4
    v_add_f32 v5, 1.0, v5
    v_rcp_f32 v12, v12
    v_rcp_f32 v15, v15
    v_rcp_f32 v4, v4
    v_rcp_f32 v5, v5
    v_mul_f32 v8, v8, v12
    v_mul_f32 v9, v9, v15
    v_mul_f32 v10, v10, v4
    v_mul_f32 v11, v11, v5
    v_cvt_pk_bf16_f32 v156, v8, v9
    v_cvt_pk_bf16_f32 v157, v10, v11
    v_lshlrev_b32 v8, 16, v136
    v_and_b32 v9, 0xffff0000, v136
    v_lshlrev_b32 v10, 16, v137
    v_and_b32 v11, 0xffff0000, v137
    v_fma_f32 v8, v8, v97, v96
    v_fma_f32 v9, v9, v97, v96
    v_fma_f32 v10, v10, v97, v96
    v_fma_f32 v11, v11, v97, v96
    v_mul_f32 v12, 0xbfb8aa3b, v8
    v_mul_f32 v15, 0xbfb8aa3b, v9
    v_mul_f32 v4, 0xbfb8aa3b, v10
    v_mul_f32 v5, 0xbfb8aa3b, v11
    v_exp_f32 v12, v12
    v_exp_f32 v15, v15
    v_exp_f32 v4, v4
    v_exp_f32 v5, v5
    v_add_f32 v12, 1.0, v12
    v_add_f32 v15, 1.0, v15
    v_add_f32 v4, 1.0, v4
    v_add_f32 v5, 1.0, v5
    v_rcp_f32 v12, v12
    v_rcp_f32 v15, v15
    v_rcp_f32 v4, v4
    v_rcp_f32 v5, v5
    v_mul_f32 v8, v8, v12
    v_mul_f32 v9, v9, v15
    v_mul_f32 v10, v10, v4
    v_mul_f32 v11, v11, v5
    v_cvt_pk_bf16_f32 v158, v8, v9
    v_cvt_pk_bf16_f32 v159, v10, v11
    v_lshlrev_b32 v8, 16, v138
    v_and_b32 v9, 0xffff0000, v138
    v_lshlrev_b32 v10, 16, v139
    v_and_b32 v11, 0xffff0000, v139
    v_fma_f32 v8, v8, v97, v96
    v_fma_f32 v9, v9, v97, v96
    v_fma_f32 v10, v10, v97, v96
    v_fma_f32 v11, v11, v97, v96
    v_mul_f32 v12, 0xbfb8aa3b, v8
    v_mul_f32 v15, 0xbfb8aa3b, v9
    v_mul_f32 v4, 0xbfb8aa3b, v10
    v_mul_f32 v5, 0xbfb8aa3b, v11
    v_exp_f32 v12, v12
    v_exp_f32 v15, v15
    v_exp_f32 v4, v4
    v_exp_f32 v5, v5
    v_add_f32 v12, 1.0, v12
    v_add_f32 v15, 1.0, v15
    v_add_f32 v4, 1.0, v4
    v_add_f32 v5, 1.0, v5
    v_rcp_f32 v12, v12
    v_rcp_f32 v15, v15
    v_rcp_f32 v4, v4
    v_rcp_f32 v5, v5
    v_mul_f32 v8, v8, v12
    v_mul_f32 v9, v9, v15
    v_mul_f32 v10, v10, v4
    v_mul_f32 v11, v11, v5
    v_cvt_pk_bf16_f32 v160, v8, v9
    v_cvt_pk_bf16_f32 v161, v10, v11
    v_lshlrev_b32 v8, 16, v140
    v_and_b32 v9, 0xffff0000, v140
    v_lshlrev_b32 v10, 16, v141
    v_and_b32 v11, 0xffff0000, v141
    v_fma_f32 v8, v8, v97, v96
    v_fma_f32 v9, v9, v97, v96
    v_fma_f32 v10, v10, v97, v96
    v_fma_f32 v11, v11, v97, v96
    v_mul_f32 v12, 0xbfb8aa3b, v8
    v_mul_f32 v15, 0xbfb8aa3b, v9
    v_mul_f32 v4, 0xbfb8aa3b, v10
    v_mul_f32 v5, 0xbfb8aa3b, v11
    v_exp_f32 v12, v12
    v_exp_f32 v15, v15
    v_exp_f32 v4, v4
    v_exp_f32 v5, v5
    v_add_f32 v12, 1.0, v12
    v_add_f32 v15, 1.0, v15
    v_add_f32 v4, 1.0, v4
    v_add_f32 v5, 1.0, v5
    v_rcp_f32 v12, v12
    v_rcp_f32 v15, v15
    v_rcp_f32 v4, v4
    v_rcp_f32 v5, v5
    v_mul_f32 v8, v8, v12
    v_mul_f32 v9, v9, v15
    v_mul_f32 v10, v10, v4
    v_mul_f32 v11, v11, v5
    v_cvt_pk_bf16_f32 v162, v8, v9
    v_cvt_pk_bf16_f32 v163, v10, v11
    v_lshlrev_b32 v8, 16, v142
    v_and_b32 v9, 0xffff0000, v142
    v_lshlrev_b32 v10, 16, v143
    v_and_b32 v11, 0xffff0000, v143
    v_fma_f32 v8, v8, v97, v96
    v_fma_f32 v9, v9, v97, v96
    v_fma_f32 v10, v10, v97, v96
    v_fma_f32 v11, v11, v97, v96
    v_mul_f32 v12, 0xbfb8aa3b, v8
    v_mul_f32 v15, 0xbfb8aa3b, v9
    v_mul_f32 v4, 0xbfb8aa3b, v10
    v_mul_f32 v5, 0xbfb8aa3b, v11
    v_exp_f32 v12, v12
    v_exp_f32 v15, v15
    v_exp_f32 v4, v4
    v_exp_f32 v5, v5
    v_add_f32 v12, 1.0, v12
    v_add_f32 v15, 1.0, v15
    v_add_f32 v4, 1.0, v4
    v_add_f32 v5, 1.0, v5
    v_rcp_f32 v12, v12
    v_rcp_f32 v15, v15
    v_rcp_f32 v4, v4
    v_rcp_f32 v5, v5
    v_mul_f32 v8, v8, v12
    v_mul_f32 v9, v9, v15
    v_mul_f32 v10, v10, v4
    v_mul_f32 v11, v11, v5
    v_cvt_pk_bf16_f32 v164, v8, v9
    v_cvt_pk_bf16_f32 v165, v10, v11
    s_branch L_p3_gback
L_p3_gsel2:
    s_waitcnt vmcnt(2)
    v_mul_f32 v96, v144, v145
    v_sub_f32 v96, 0, v96
    v_mov_b32 v97, v145
    v_lshlrev_b32 v8, 16, v128
    v_and_b32 v9, 0xffff0000, v128
    v_lshlrev_b32 v10, 16, v129
    v_and_b32 v11, 0xffff0000, v129
    v_fma_f32 v8, v8, v97, v96
    v_fma_f32 v9, v9, v97, v96
    v_fma_f32 v10, v10, v97, v96
    v_fma_f32 v11, v11, v97, v96
    v_cvt_pk_bf16_f32 v4, v64, v65
    v_lshlrev_b32 v12, 16, v4
    v_and_b32 v15, 0xffff0000, v4
    v_fmac_f32 v8, v12, v90
    v_fmac_f32 v9, v15, v90
    v_cvt_pk_bf16_f32 v4, v66, v67
    v_lshlrev_b32 v12, 16, v4
    v_and_b32 v15, 0xffff0000, v4
    v_fmac_f32 v10, v12, v90
    v_fmac_f32 v11, v15, v90
    v_mul_f32 v12, 0xbfb8aa3b, v8
    v_mul_f32 v15, 0xbfb8aa3b, v9
    v_mul_f32 v4, 0xbfb8aa3b, v10
    v_mul_f32 v5, 0xbfb8aa3b, v11
    v_exp_f32 v12, v12
    v_exp_f32 v15, v15
    v_exp_f32 v4, v4
    v_exp_f32 v5, v5
    v_add_f32 v12, 1.0, v12
    v_add_f32 v15, 1.0, v15
    v_add_f32 v4, 1.0, v4
    v_add_f32 v5, 1.0, v5
    v_rcp_f32 v12, v12
    v_rcp_f32 v15, v15
    v_rcp_f32 v4, v4
    v_rcp_f32 v5, v5
    v_mul_f32 v8, v8, v12
    v_mul_f32 v9, v9, v15
    v_mul_f32 v10, v10, v4
    v_mul_f32 v11, v11, v5
    v_cvt_pk_bf16_f32 v150, v8, v9
    v_cvt_pk_bf16_f32 v151, v10, v11
    v_lshlrev_b32 v8, 16, v130
    v_and_b32 v9, 0xffff0000, v130
    v_lshlrev_b32 v10, 16, v131
    v_and_b32 v11, 0xffff0000, v131
    v_fma_f32 v8, v8, v97, v96
    v_fma_f32 v9, v9, v97, v96
    v_fma_f32 v10, v10, v97, v96
    v_fma_f32 v11, v11, v97, v96
    v_cvt_pk_bf16_f32 v4, v68, v69
    v_lshlrev_b32 v12, 16, v4
    v_and_b32 v15, 0xffff0000, v4
    v_fmac_f32 v8, v12, v90
    v_fmac_f32 v9, v15, v90
    v_cvt_pk_bf16_f32 v4, v70, v71
    v_lshlrev_b32 v12, 16, v4
    v_and_b32 v15, 0xffff0000, v4
    v_fmac_f32 v10, v12, v90
    v_fmac_f32 v11, v15, v90
    v_mul_f32 v12, 0xbfb8aa3b, v8
    v_mul_f32 v15, 0xbfb8aa3b, v9
    v_mul_f32 v4, 0xbfb8aa3b, v10
    v_mul_f32 v5, 0xbfb8aa3b, v11
    v_exp_f32 v12, v12
    v_exp_f32 v15, v15
    v_exp_f32 v4, v4
    v_exp_f32 v5, v5
    v_add_f32 v12, 1.0, v12
    v_add_f32 v15, 1.0, v15
    v_add_f32 v4, 1.0, v4
    v_add_f32 v5, 1.0, v5
    v_rcp_f32 v12, v12
    v_rcp_f32 v15, v15
    v_rcp_f32 v4, v4
    v_rcp_f32 v5, v5
    v_mul_f32 v8, v8, v12
    v_mul_f32 v9, v9, v15
    v_mul_f32 v10, v10, v4
    v_mul_f32 v11, v11, v5
    v_cvt_pk_bf16_f32 v152, v8, v9
    v_cvt_pk_bf16_f32 v153, v10, v11
    v_lshlrev_b32 v8, 16, v132
    v_and_b32 v9, 0xffff0000, v132
    v_lshlrev_b32 v10, 16, v133
    v_and_b32 v11, 0xffff0000, v133
    v_fma_f32 v8, v8, v97, v96
    v_fma_f32 v9, v9, v97, v96
    v_fma_f32 v10, v10, v97, v96
    v_fma_f32 v11, v11, v97, v96
    v_cvt_pk_bf16_f32 v4, v72, v73
    v_lshlrev_b32 v12, 16, v4
    v_and_b32 v15, 0xffff0000, v4
    v_fmac_f32 v8, v12, v90
    v_fmac_f32 v9, v15, v90
    v_cvt_pk_bf16_f32 v4, v74, v75
    v_lshlrev_b32 v12, 16, v4
    v_and_b32 v15, 0xffff0000, v4
    v_fmac_f32 v10, v12, v90
    v_fmac_f32 v11, v15, v90
    v_mul_f32 v12, 0xbfb8aa3b, v8
    v_mul_f32 v15, 0xbfb8aa3b, v9
    v_mul_f32 v4, 0xbfb8aa3b, v10
    v_mul_f32 v5, 0xbfb8aa3b, v11
    v_exp_f32 v12, v12
    v_exp_f32 v15, v15
    v_exp_f32 v4, v4
    v_exp_f32 v5, v5
    v_add_f32 v12, 1.0, v12
    v_add_f32 v15, 1.0, v15
    v_add_f32 v4, 1.0, v4
    v_add_f32 v5, 1.0, v5
    v_rcp_f32 v12, v12
    v_rcp_f32 v15, v15
    v_rcp_f32 v4, v4
    v_rcp_f32 v5, v5
    v_mul_f32 v8, v8, v12
    v_mul_f32 v9, v9, v15
    v_mul_f32 v10, v10, v4
    v_mul_f32 v11, v11, v5
    v_cvt_pk_bf16_f32 v154, v8, v9
    v_cvt_pk_bf16_f32 v155, v10, v11
    v_lshlrev_b32 v8, 16, v134
    v_and_b32 v9, 0xffff0000, v134
    v_lshlrev_b32 v10, 16, v135
    v_and_b32 v11, 0xffff0000, v135
    v_fma_f32 v8, v8, v97, v96
    v_fma_f32 v9, v9, v97, v96
    v_fma_f32 v10, v10, v97, v96
    v_fma_f32 v11, v11, v97, v96
    v_cvt_pk_bf16_f32 v4, v76, v77
    v_lshlrev_b32 v12, 16, v4
    v_and_b32 v15, 0xffff0000, v4
    v_fmac_f32 v8, v12, v90
    v_fmac_f32 v9, v15, v90
    v_cvt_pk_bf16_f32 v4, v78, v79
    v_lshlrev_b32 v12, 16, v4
    v_and_b32 v15, 0xffff0000, v4
    v_fmac_f32 v10, v12, v90
    v_fmac_f32 v11, v15, v90
    v_mul_f32 v12, 0xbfb8aa3b, v8
    v_mul_f32 v15, 0xbfb8aa3b, v9
    v_mul_f32 v4, 0xbfb8aa3b, v10
    v_mul_f32 v5, 0xbfb8aa3b, v11
    v_exp_f32 v12, v12
    v_exp_f32 v15, v15
    v_exp_f32 v4, v4
    v_exp_f32 v5, v5
    v_add_f32 v12, 1.0, v12
    v_add_f32 v15, 1.0, v15
    v_add_f32 v4, 1.0, v4
    v_add_f32 v5, 1.0, v5
    v_rcp_f32 v12, v12
    v_rcp_f32 v15, v15
    v_rcp_f32 v4, v4
    v_rcp_f32 v5, v5
    v_mul_f32 v8, v8, v12
    v_mul_f32 v9, v9, v15
    v_mul_f32 v10, v10, v4
    v_mul_f32 v11, v11, v5
    v_cvt_pk_bf16_f32 v156, v8, v9
    v_cvt_pk_bf16_f32 v157, v10, v11
    v_lshlrev_b32 v8, 16, v136
    v_and_b32 v9, 0xffff0000, v136
    v_lshlrev_b32 v10, 16, v137
    v_and_b32 v11, 0xffff0000, v137
    v_fma_f32 v8, v8, v97, v96
    v_fma_f32 v9, v9, v97, v96
    v_fma_f32 v10, v10, v97, v96
    v_fma_f32 v11, v11, v97, v96
    v_cvt_pk_bf16_f32 v4, v24, v25
    v_lshlrev_b32 v12, 16, v4
    v_and_b32 v15, 0xffff0000, v4
    v_fmac_f32 v8, v12, v90
    v_fmac_f32 v9, v15, v90
    v_cvt_pk_bf16_f32 v4, v26, v27
    v_lshlrev_b32 v12, 16, v4
    v_and_b32 v15, 0xffff0000, v4
    v_fmac_f32 v10, v12, v90
    v_fmac_f32 v11, v15, v90
    v_mul_f32 v12, 0xbfb8aa3b, v8
    v_mul_f32 v15, 0xbfb8aa3b, v9
    v_mul_f32 v4, 0xbfb8aa3b, v10
    v_mul_f32 v5, 0xbfb8aa3b, v11
    v_exp_f32 v12, v12
    v_exp_f32 v15, v15
    v_exp_f32 v4, v4
    v_exp_f32 v5, v5
    v_add_f32 v12, 1.0, v12
    v_add_f32 v15, 1.0, v15
    v_add_f32 v4, 1.0, v4
    v_add_f32 v5, 1.0, v5
    v_rcp_f32 v12, v12
    v_rcp_f32 v15, v15
    v_rcp_f32 v4, v4
    v_rcp_f32 v5, v5
    v_mul_f32 v8, v8, v12
    v_mul_f32 v9, v9, v15
    v_mul_f32 v10, v10, v4
    v_mul_f32 v11, v11, v5
    v_cvt_pk_bf16_f32 v158, v8, v9
    v_cvt_pk_bf16_f32 v159, v10, v11
    v_lshlrev_b32 v8, 16, v138
    v_and_b32 v9, 0xffff0000, v138
    v_lshlrev_b32 v10, 16, v139
    v_and_b32 v11, 0xffff0000, v139
    v_fma_f32 v8, v8, v97, v96
    v_fma_f32 v9, v9, v97, v96
    v_fma_f32 v10, v10, v97, v96
    v_fma_f32 v11, v11, v97, v96
    v_cvt_pk_bf16_f32 v4, v28, v29
    v_lshlrev_b32 v12, 16, v4
    v_and_b32 v15, 0xffff0000, v4
    v_fmac_f32 v8, v12, v90
    v_fmac_f32 v9, v15, v90
    v_cvt_pk_bf16_f32 v4, v30, v31
    v_lshlrev_b32 v12, 16, v4
    v_and_b32 v15, 0xffff0000, v4
    v_fmac_f32 v10, v12, v90
    v_fmac_f32 v11, v15, v90
    v_mul_f32 v12, 0xbfb8aa3b, v8
    v_mul_f32 v15, 0xbfb8aa3b, v9
    v_mul_f32 v4, 0xbfb8aa3b, v10
    v_mul_f32 v5, 0xbfb8aa3b, v11
    v_exp_f32 v12, v12
    v_exp_f32 v15, v15
    v_exp_f32 v4, v4
    v_exp_f32 v5, v5
    v_add_f32 v12, 1.0, v12
    v_add_f32 v15, 1.0, v15
    v_add_f32 v4, 1.0, v4
    v_add_f32 v5, 1.0, v5
    v_rcp_f32 v12, v12
    v_rcp_f32 v15, v15
    v_rcp_f32 v4, v4
    v_rcp_f32 v5, v5
    v_mul_f32 v8, v8, v12
    v_mul_f32 v9, v9, v15
    v_mul_f32 v10, v10, v4
    v_mul_f32 v11, v11, v5
    v_cvt_pk_bf16_f32 v160, v8, v9
    v_cvt_pk_bf16_f32 v161, v10, v11
    v_lshlrev_b32 v8, 16, v140
    v_and_b32 v9, 0xffff0000, v140
    v_lshlrev_b32 v10, 16, v141
    v_and_b32 v11, 0xffff0000, v141
    v_fma_f32 v8, v8, v97, v96
    v_fma_f32 v9, v9, v97, v96
    v_fma_f32 v10, v10, v97, v96
    v_fma_f32 v11, v11, v97, v96
    v_cvt_pk_bf16_f32 v4, v32, v33
    v_lshlrev_b32 v12, 16, v4
    v_and_b32 v15, 0xffff0000, v4
    v_fmac_f32 v8, v12, v90
    v_fmac_f32 v9, v15, v90
    v_cvt_pk_bf16_f32 v4, v34, v35
    v_lshlrev_b32 v12, 16, v4
    v_and_b32 v15, 0xffff0000, v4
    v_fmac_f32 v10, v12, v90
    v_fmac_f32 v11, v15, v90
    v_mul_f32 v12, 0xbfb8aa3b, v8
    v_mul_f32 v15, 0xbfb8aa3b, v9
    v_mul_f32 v4, 0xbfb8aa3b, v10
    v_mul_f32 v5, 0xbfb8aa3b, v11
    v_exp_f32 v12, v12
    v_exp_f32 v15, v15
    v_exp_f32 v4, v4
    v_exp_f32 v5, v5
    v_add_f32 v12, 1.0, v12
    v_add_f32 v15, 1.0, v15
    v_add_f32 v4, 1.0, v4
    v_add_f32 v5, 1.0, v5
    v_rcp_f32 v12, v12
    v_rcp_f32 v15, v15
    v_rcp_f32 v4, v4
    v_rcp_f32 v5, v5
    v_mul_f32 v8, v8, v12
    v_mul_f32 v9, v9, v15
    v_mul_f32 v10, v10, v4
    v_mul_f32 v11, v11, v5
    v_cvt_pk_bf16_f32 v162, v8, v9
    v_cvt_pk_bf16_f32 v163, v10, v11
    v_lshlrev_b32 v8, 16, v142
    v_and_b32 v9, 0xffff0000, v142
    v_lshlrev_b32 v10, 16, v143
    v_and_b32 v11, 0xffff0000, v143
    v_fma_f32 v8, v8, v97, v96
    v_fma_f32 v9, v9, v97, v96
    v_fma_f32 v10, v10, v97, v96
    v_fma_f32 v11, v11, v97, v96
    v_cvt_pk_bf16_f32 v4, v36, v37
    v_lshlrev_b32 v12, 16, v4
    v_and_b32 v15, 0xffff0000, v4
    v_fmac_f32 v8, v12, v90
    v_fmac_f32 v9, v15, v90
    v_cvt_pk_bf16_f32 v4, v38, v39
    v_lshlrev_b32 v12, 16, v4
    v_and_b32 v15, 0xffff0000, v4
    v_fmac_f32 v10, v12, v90
    v_fmac_f32 v11, v15, v90
    v_mul_f32 v12, 0xbfb8aa3b, v8
    v_mul_f32 v15, 0xbfb8aa3b, v9
    v_mul_f32 v4, 0xbfb8aa3b, v10
    v_mul_f32 v5, 0xbfb8aa3b, v11
    v_exp_f32 v12, v12
    v_exp_f32 v15, v15
    v_exp_f32 v4, v4
    v_exp_f32 v5, v5
    v_add_f32 v12, 1.0, v12
    v_add_f32 v15, 1.0, v15
    v_add_f32 v4, 1.0, v4
    v_add_f32 v5, 1.0, v5
    v_rcp_f32 v12, v12
    v_rcp_f32 v15, v15
    v_rcp_f32 v4, v4
    v_rcp_f32 v5, v5
    v_mul_f32 v8, v8, v12
    v_mul_f32 v9, v9, v15
    v_mul_f32 v10, v10, v4
    v_mul_f32 v11, v11, v5
    v_cvt_pk_bf16_f32 v164, v8, v9
    v_cvt_pk_bf16_f32 v165, v10, v11
    s_branch L_p3_gback
L_c_end:
L_aux:
    s_sub_u32 s34, s22, 8
    s_sub_u32 s50, s22, 6
    s_lshl_b32 s50, s50, 1
    s_lshl_b32 s35, s33, 3
    s_add_u32 s50, s50, s35
    s_lshl_b32 s35, s32, 7
    s_add_u32 s50, s50, s35
    s_lshl_b32 s51, s50, 11
    v_lshlrev_b32 v2, 4, v1
    s_waitcnt lgkmcnt(0)
    s_mov_b32 s8, s4
    s_mov_b32 s9, s5
    s_mov_b32 s10, 4194304
    s_mov_b32 s11, 0x20000
    s_add_u32 s24, s46, 20971520
    s_addc_u32 s25, s47, 0
    s_mov_b32 s26, 1048576
    s_mov_b32 s27, 0x20000
    s_mov_b32 s28, s44
    s_mov_b32 s29, s45
    s_mov_b32 s30, 256
    s_mov_b32 s31, 0x20000
    s_mov_b32 s36, s42
    s_mov_b32 s37, s43
    s_mov_b32 s38, 2048
    s_mov_b32 s39, 0x20000
    s_cmp_eq_u32 s34, 2
    s_cbranch_scc0 L_g_46
    s_mul_i32 s35, s2, 2944
    s_add_u32 s35, s35, 0
    v_mov_b32 v24, 0
    v_mov_b32 v25, 0
    v_mov_b32 v26, 0
    v_mov_b32 v27, 0
    buffer_store_dwordx4 v[24:27], v2, s[24:27], s35 offen sc1
    buffer_store_dwordx4 v[24:27], v2, s[24:27], s35 offen offset:1024 sc1
    s_mov_b32 exec_hi, 0x00ffffff
    buffer_store_dwordx4 v[24:27], v2, s[24:27], s35 offen offset:2048 sc1
    s_mov_b64 exec, -1
L_g_46:
    s_lshr_b32 s52, s32, 2
    s_cmp_eq_u32 s52, 3
    s_cselect_b32 s53, 0, s52
    s_mul_i32 s53, s53, 40960
    s_add_u32 s53, s53, 4096
    v_lshrrev_b32 v12, 4, v1
    v_bfe_u32 v13, v1, 2, 2
    v_lshrrev_b32 v14, 1, v12
    v_mul_u32_u24 v14, 10240, v14
    v_and_b32 v15, 1, v12
    v_lshl_add_u32 v15, v15, 3, v13
    v_lshl_add_u32 v14, v15, 7, v14
    v_and_b32 v15, 1, v1
    v_lshl_add_u32 v14, v15, 3, v14
    v_add_u32 v14, s53, v14
    v_bfe_u32 v15, v1, 1, 1
    v_lshrrev_b32 v13, 1, v13
    v_lshl_or_b32 v15, v13, 2, v15
    s_mul_i32 s35, s34, 3
    v_mov_b32 v28, 0x3f803f80
    v_mov_b32 v29, 0x3f803f80
    v_mov_b32 v30, 0x3f803f80
    v_mov_b32 v31, 0x3f803f80
    s_add_u32 s40, s35, 0
    s_and_b32 s41, s40, 3
    s_lshl_b32 s41, s41, 1
    s_lshr_b32 s40, s40, 2
    s_lshl_b32 s40, s40, 11
    v_xor_b32 v16, s41, v15
    v_lshl_add_u32 v16, v16, 4, v14
    v_add_u32 v16, s40, v16
    s_add_u32 s40, s35, 1
    s_and_b32 s41, s40, 3
    s_lshl_b32 s41, s41, 1
    s_lshr_b32 s40, s40, 2
    s_lshl_b32 s40, s40, 11
    v_xor_b32 v17, s41, v15
    v_lshl_add_u32 v17, v17, 4, v14
    v_add_u32 v17, s40, v17
    s_add_u32 s40, s35, 2
    s_and_b32 s41, s40, 3
    s_lshl_b32 s41, s41, 1
    s_lshr_b32 s40, s40, 2
    s_lshl_b32 s40, s40, 11
    v_xor_b32 v18, s41, v15
    v_lshl_add_u32 v18, v18, 4, v14
    v_add_u32 v18, s40, v18
    s_barrier
    s_cmp_eq_u32 s52, 0
    s_cbranch_scc0 L_g_49
    ds_read_b64_tr_b16 v[40:41], v16 offset:0
    ds_read_b64_tr_b16 v[42:43], v16 offset:512
    ds_read_b64_tr_b16 v[44:45], v16 offset:20480
    ds_read_b64_tr_b16 v[46:47], v16 offset:20992
    ds_read_b64_tr_b16 v[48:49], v17 offset:0
    ds_read_b64_tr_b16 v[50:51], v17 offset:512
    ds_read_b64_tr_b16 v[52:53], v17 offset:20480
    ds_read_b64_tr_b16 v[54:55], v17 offset:20992
    ds_read_b64_tr_b16 v[56:57], v18 offset:0
    ds_read_b64_tr_b16 v[58:59], v18 offset:512
    ds_read_b64_tr_b16 v[60:61], v18 offset:20480
    ds_read_b64_tr_b16 v[62:63], v18 offset:20992
    s_waitcnt lgkmcnt(0)
    v_mfma_f32_16x16x32_bf16 v[96:99], v[28:31], v[40:43], 0
    v_mfma_f32_16x16x32_bf16 v[100:103], v[28:31], v[48:51], 0
    v_mfma_f32_16x16x32_bf16 v[104:107], v[28:31], v[56:59], 0
    v_mfma_f32_16x16x32_bf16 v[96:99], v[28:31], v[44:47], v[96:99]
    v_mfma_f32_16x16x32_bf16 v[100:103], v[28:31], v[52:55], v[100:103]
    v_mfma_f32_16x16x32_bf16 v[104:107], v[28:31], v[60:63], v[104:107]
L_g_49:
    s_cmp_eq_u32 s34, 2
    s_cbranch_scc0 L_g_53
    s_waitcnt vmcnt(0)
    s_and_b32 s35, s2, 1
    s_lshl_b32 s35, s35, 7
    v_mov_b32 v24, 1
    s_mov_b64 exec, 1
    buffer_atomic_add v24, off, s[28:31], s35 sc1
    s_mov_b64 exec, -1
L_g_53:
    s_barrier
    s_cmp_eq_u32 s52, 1
    s_cbranch_scc0 L_g_50
    ds_read_b64_tr_b16 v[40:41], v16 offset:0
    ds_read_b64_tr_b16 v[42:43], v16 offset:512
    ds_read_b64_tr_b16 v[44:45], v16 offset:20480
    ds_read_b64_tr_b16 v[46:47], v16 offset:20992
    ds_read_b64_tr_b16 v[48:49], v17 offset:0
    ds_read_b64_tr_b16 v[50:51], v17 offset:512
    ds_read_b64_tr_b16 v[52:53], v17 offset:20480
    ds_read_b64_tr_b16 v[54:55], v17 offset:20992
    ds_read_b64_tr_b16 v[56:57], v18 offset:0
    ds_read_b64_tr_b16 v[58:59], v18 offset:512
    ds_read_b64_tr_b16 v[60:61], v18 offset:20480
    ds_read_b64_tr_b16 v[62:63], v18 offset:20992
    s_waitcnt lgkmcnt(0)
    v_mfma_f32_16x16x32_bf16 v[96:99], v[28:31], v[40:43], 0
    v_mfma_f32_16x16x32_bf16 v[100:103], v[28:31], v[48:51], 0
    v_mfma_f32_16x16x32_bf16 v[104:107], v[28:31], v[56:59], 0
    v_mfma_f32_16x16x32_bf16 v[96:99], v[28:31], v[44:47], v[96:99]
    v_mfma_f32_16x16x32_bf16 v[100:103], v[28:31], v[52:55], v[100:103]
    v_mfma_f32_16x16x32_bf16 v[104:107], v[28:31], v[60:63], v[104:107]
L_g_50:
    s_barrier
    s_cmp_eq_u32 s52, 2
    s_cbranch_scc0 L_g_51
    ds_read_b64_tr_b16 v[40:41], v16 offset:0
    ds_read_b64_tr_b16 v[42:43], v16 offset:512
    ds_read_b64_tr_b16 v[44:45], v16 offset:20480
    ds_read_b64_tr_b16 v[46:47], v16 offset:20992
    ds_read_b64_tr_b16 v[48:49], v17 offset:0
    ds_read_b64_tr_b16 v[50:51], v17 offset:512
    ds_read_b64_tr_b16 v[52:53], v17 offset:20480
    ds_read_b64_tr_b16 v[54:55], v17 offset:20992
    ds_read_b64_tr_b16 v[56:57], v18 offset:0
    ds_read_b64_tr_b16 v[58:59], v18 offset:512
    ds_read_b64_tr_b16 v[60:61], v18 offset:20480
    ds_read_b64_tr_b16 v[62:63], v18 offset:20992
    s_waitcnt lgkmcnt(0)
    v_mfma_f32_16x16x32_bf16 v[96:99], v[28:31], v[40:43], 0
    v_mfma_f32_16x16x32_bf16 v[100:103], v[28:31], v[48:51], 0
    v_mfma_f32_16x16x32_bf16 v[104:107], v[28:31], v[56:59], 0
    v_mfma_f32_16x16x32_bf16 v[96:99], v[28:31], v[44:47], v[96:99]
    v_mfma_f32_16x16x32_bf16 v[100:103], v[28:31], v[52:55], v[100:103]
    v_mfma_f32_16x16x32_bf16 v[104:107], v[28:31], v[60:63], v[104:107]
L_g_51:
    s_barrier
    s_cmp_eq_u32 s52, 3
    s_cbranch_scc0 L_g_52
    ds_read_b64_tr_b16 v[40:41], v16 offset:0
    ds_read_b64_tr_b16 v[42:43], v16 offset:512
    ds_read_b64_tr_b16 v[44:45], v16 offset:20480
    ds_read_b64_tr_b16 v[46:47], v16 offset:20992
    ds_read_b64_tr_b16 v[48:49], v17 offset:0
    ds_read_b64_tr_b16 v[50:51], v17 offset:512
    ds_read_b64_tr_b16 v[52:53], v17 offset:20480
    ds_read_b64_tr_b16 v[54:55], v17 offset:20992
    ds_read_b64_tr_b16 v[56:57], v18 offset:0
    ds_read_b64_tr_b16 v[58:59], v18 offset:512
    ds_read_b64_tr_b16 v[60:61], v18 offset:20480
    ds_read_b64_tr_b16 v[62:63], v18 offset:20992
    s_waitcnt lgkmcnt(0)
    v_mfma_f32_16x16x32_bf16 v[96:99], v[28:31], v[40:43], 0
    v_mfma_f32_16x16x32_bf16 v[100:103], v[28:31], v[48:51], 0
    v_mfma_f32_16x16x32_bf16 v[104:107], v[28:31], v[56:59], 0
    v_mfma_f32_16x16x32_bf16 v[96:99], v[28:31], v[44:47], v[96:99]
    v_mfma_f32_16x16x32_bf16 v[100:103], v[28:31], v[52:55], v[100:103]
    v_mfma_f32_16x16x32_bf16 v[104:107], v[28:31], v[60:63], v[104:107]
L_g_52:
    s_cmp_lt_u32 s34, 2
    s_cbranch_scc0 L_g_54
    buffer_load_dwordx4 v[64:67], v2, s[8:11], s51 offen offset:0
    buffer_load_dwordx4 v[68:71], v2, s[8:11], s51 offen offset:1024
    buffer_load_dwordx4 v[72:75], v2, s[8:11], s51 offen offset:2048
    buffer_load_dwordx4 v[76:79], v2, s[8:11], s51 offen offset:3072
    buffer_load_dwordx4 v[4:7], v2, s[36:39], 0 offen
    buffer_load_dwordx4 v[8:11], v2, s[36:39], 0 offen offset:1024
L_g_54:
    s_cmp_eq_u32 s34, 2
    s_cbranch_scc0 L_g_55
    buffer_load_dword v24, off, s[28:31], 0 sc1
    buffer_load_dword v25, off, s[28:31], 0 offset:128 sc1
L_g_55:
    s_barrier
    s_barrier
    s_cmp_lt_u32 s34, 2
    s_cbranch_scc0 L_g_56
    s_waitcnt vmcnt(0)
    v_lshlrev_b32 v80, 16, v4
    v_and_b32 v81, 0xffff0000, v4
    v_lshlrev_b32 v82, 16, v5
    v_and_b32 v83, 0xffff0000, v5
    v_lshlrev_b32 v84, 16, v6
    v_and_b32 v85, 0xffff0000, v6
    v_lshlrev_b32 v86, 16, v7
    v_and_b32 v87, 0xffff0000, v7
    v_lshlrev_b32 v88, 16, v8
    v_and_b32 v89, 0xffff0000, v8
    v_lshlrev_b32 v90, 16, v9
    v_and_b32 v91, 0xffff0000, v9
    v_lshlrev_b32 v92, 16, v10
    v_and_b32 v93, 0xffff0000, v10
    v_lshlrev_b32 v94, 16, v11
    v_and_b32 v95, 0xffff0000, v11
    v_add_f32 v38, v80, v81
    v_add_f32 v38, v38, v82
    v_add_f32 v38, v38, v83
    v_add_f32 v38, v38, v84
    v_add_f32 v38, v38, v85
    v_add_f32 v38, v38, v86
    v_add_f32 v38, v38, v87
    v_add_f32 v38, v38, v88
    v_add_f32 v38, v38, v89
    v_add_f32 v38, v38, v90
    v_add_f32 v38, v38, v91
    v_add_f32 v38, v38, v92
    v_add_f32 v38, v38, v93
    v_add_f32 v38, v38, v94
    v_add_f32 v38, v38, v95
    v_lshlrev_b32 v24, 16, v64
    v_and_b32 v25, 0xffff0000, v64
    v_add_f32 v32, v24, v25
    v_mul_f32 v34, v24, v24
    v_mul_f32 v36, v24, v80
    v_fmac_f32 v34, v25, v25
    v_fmac_f32 v36, v25, v81
    v_lshlrev_b32 v26, 16, v65
    v_and_b32 v27, 0xffff0000, v65
    v_add_f32 v32, v32, v26
    v_fmac_f32 v34, v26, v26
    v_fmac_f32 v36, v26, v82
    v_add_f32 v32, v32, v27
    v_fmac_f32 v34, v27, v27
    v_fmac_f32 v36, v27, v83
    v_lshlrev_b32 v24, 16, v66
    v_and_b32 v25, 0xffff0000, v66
    v_add_f32 v32, v32, v24
    v_fmac_f32 v34, v24, v24
    v_fmac_f32 v36, v24, v84
    v_add_f32 v32, v32, v25
    v_fmac_f32 v34, v25, v25
    v_fmac_f32 v36, v25, v85
    v_lshlrev_b32 v26, 16, v67
    v_and_b32 v27, 0xffff0000, v67
    v_add_f32 v32, v32, v26
    v_fmac_f32 v34, v26, v26
    v_fmac_f32 v36, v26, v86
    v_add_f32 v32, v32, v27
    v_fmac_f32 v34, v27, v27
    v_fmac_f32 v36, v27, v87
    v_lshlrev_b32 v24, 16, v68
    v_and_b32 v25, 0xffff0000, v68
    v_add_f32 v32, v32, v24
    v_fmac_f32 v34, v24, v24
    v_fmac_f32 v36, v24, v88
    v_add_f32 v32, v32, v25
    v_fmac_f32 v34, v25, v25
    v_fmac_f32 v36, v25, v89
    v_lshlrev_b32 v26, 16, v69
    v_and_b32 v27, 0xffff0000, v69
    v_add_f32 v32, v32, v26
    v_fmac_f32 v34, v26, v26
    v_fmac_f32 v36, v26, v90
    v_add_f32 v32, v32, v27
    v_fmac_f32 v34, v27, v27
L_g_56:
    s_cmp_eq_u32 s34, 2
    s_cbranch_scc0 L_g_58
    s_mov_b32 s61, 262144
L_rt_47:
    s_waitcnt vmcnt(0)
    v_add_u32 v24, v24, v25
    s_nop 0
    v_readfirstlane_b32 s60, v24
    s_nop 0
    s_cmp_ge_u32 s60, 256
    s_cbranch_scc1 L_rte_48
    s_sleep 8
    buffer_load_dword v24, off, s[28:31], 0 sc1
    buffer_load_dword v25, off, s[28:31], 0 offset:128 sc1
    s_sub_u32 s61, s61, 1
    s_cmp_lg_u32 s61, 0
    s_cbranch_scc1 L_rt_47
    s_waitcnt vmcnt(0)
L_rte_48:
L_g_58:
    s_barrier
    s_cmp_lt_u32 s34, 2
    s_cbranch_scc0 L_g_57
    v_fmac_f32 v36, v27, v91
    v_lshlrev_b32 v24, 16, v70
    v_and_b32 v25, 0xffff0000, v70
    v_add_f32 v32, v32, v24
    v_fmac_f32 v34, v24, v24
    v_fmac_f32 v36, v24, v92
    v_add_f32 v32, v32, v25
    v_fmac_f32 v34, v25, v25
    v_fmac_f32 v36, v25, v93
    v_lshlrev_b32 v26, 16, v71
    v_and_b32 v27, 0xffff0000, v71
    v_add_f32 v32, v32, v26
    v_fmac_f32 v34, v26, v26
    v_fmac_f32 v36, v26, v94
    v_add_f32 v32, v32, v27
    v_fmac_f32 v34, v27, v27
    v_fmac_f32 v36, v27, v95
    v_lshlrev_b32 v24, 16, v72
    v_and_b32 v25, 0xffff0000, v72
    v_add_f32 v33, v24, v25
    v_mul_f32 v35, v24, v24
    v_mul_f32 v37, v24, v80
    v_fmac_f32 v35, v25, v25
    v_fmac_f32 v37, v25, v81
    v_lshlrev_b32 v26, 16, v73
    v_and_b32 v27, 0xffff0000, v73
    v_add_f32 v33, v33, v26
    v_fmac_f32 v35, v26, v26
    v_fmac_f32 v37, v26, v82
    v_add_f32 v33, v33, v27
    v_fmac_f32 v35, v27, v27
    v_fmac_f32 v37, v27, v83
    v_lshlrev_b32 v24, 16, v74
    v_and_b32 v25, 0xffff0000, v74
    v_add_f32 v33, v33, v24
    v_fmac_f32 v35, v24, v24
    v_fmac_f32 v37, v24, v84
    v_add_f32 v33, v33, v25
    v_fmac_f32 v35, v25, v25
    v_fmac_f32 v37, v25, v85
    v_lshlrev_b32 v26, 16, v75
    v_and_b32 v27, 0xffff0000, v75
    v_add_f32 v33, v33, v26
    v_fmac_f32 v35, v26, v26
    v_fmac_f32 v37, v26, v86
    v_add_f32 v33, v33, v27
    v_fmac_f32 v35, v27, v27
    v_fmac_f32 v37, v27, v87
    v_lshlrev_b32 v24, 16, v76
    v_and_b32 v25, 0xffff0000, v76
    v_add_f32 v33, v33, v24
    v_fmac_f32 v35, v24, v24
    v_fmac_f32 v37, v24, v88
    v_add_f32 v33, v33, v25
    v_fmac_f32 v35, v25, v25
    v_fmac_f32 v37, v25, v89
    v_lshlrev_b32 v26, 16, v77
    v_and_b32 v27, 0xffff0000, v77
    v_add_f32 v33, v33, v26
    v_fmac_f32 v35, v26, v26
    v_fmac_f32 v37, v26, v90
    v_add_f32 v33, v33, v27
    v_fmac_f32 v35, v27, v27
    v_fmac_f32 v37, v27, v91
    v_lshlrev_b32 v24, 16, v78
    v_and_b32 v25, 0xffff0000, v78
    v_add_f32 v33, v33, v24
    v_fmac_f32 v35, v24, v24
    v_fmac_f32 v37, v24, v92
    v_add_f32 v33, v33, v25
    v_fmac_f32 v35, v25, v25
    v_fmac_f32 v37, v25, v93
    v_lshlrev_b32 v26, 16, v79
    v_and_b32 v27, 0xffff0000, v79
    v_add_f32 v33, v33, v26
    v_fmac_f32 v35, v26, v26
    v_fmac_f32 v37, v26, v94
    v_add_f32 v33, v33, v27
L_g_57:
    s_lshl_b32 s35, s33, 4
    s_add_u32 s35, s35, s32
    s_mul_i32 s35, s35, 768
    s_mul_i32 s40, s34, 192
    s_add_u32 s35, s35, s40
    s_add_u32 s35, s35, 294912
    v_lshlrev_b32 v16, 2, v1
    v_cmp_eq_u32 vcc, 1, v12
    v_cmp_eq_u32 s[40:41], 2, v12
    s_nop 1
    v_cndmask_b32 v96, v96, v100, vcc
    v_cndmask_b32 v96, v96, v104, s[40:41]
    v_or_b32 v96, 1, v96
    s_mov_b32 exec_hi, 0xffff
    buffer_store_dword v96, v16, s[24:27], s35 offen sc1
    s_mov_b64 exec, -1
    s_barrier
    s_cmp_lt_u32 s34, 2
    s_cbranch_scc0 L_g_59
    v_fmac_f32 v35, v27, v27
    v_fmac_f32 v37, v27, v95
    v_mov_b32 v39, v38
    s_nop 1
    v_permlane32_swap_b32 v32, v33
    v_permlane32_swap_b32 v34, v35
    v_permlane32_swap_b32 v36, v37
    v_permlane32_swap_b32 v38, v39
    s_nop 1
    v_add_f32 v32, v32, v33
    v_add_f32 v34, v34, v35
    v_add_f32 v36, v36, v37
    v_add_f32 v38, v38, v39
    v_mov_b32 v33, v32
    v_mov_b32 v35, v34
    v_mov_b32 v37, v36
    v_mov_b32 v39, v38
    s_nop 1
    v_permlane16_swap_b32 v32, v33
    v_permlane16_swap_b32 v34, v35
    v_permlane16_swap_b32 v36, v37
    v_permlane16_swap_b32 v38, v39
    s_nop 1
    v_add_f32 v32, v32, v33
    v_add_f32 v34, v34, v35
    v_add_f32 v36, v36, v37
    v_add_f32 v38, v38, v39
    s_nop 0
    v_add_f32_dpp v32, v32, v32 quad_perm:[1,0,3,2] row_mask:0xf bank_mask:0xf
    v_add_f32_dpp v34, v34, v34 quad_perm:[1,0,3,2] row_mask:0xf bank_mask:0xf
    v_add_f32_dpp v36, v36, v36 quad_perm:[1,0,3,2] row_mask:0xf bank_mask:0xf
    v_add_f32_dpp v38, v38, v38 quad_perm:[1,0,3,2] row_mask:0xf bank_mask:0xf
    s_nop 0
    v_add_f32_dpp v32, v32, v32 quad_perm:[2,3,0,1] row_mask:0xf bank_mask:0xf
    v_add_f32_dpp v34, v34, v34 quad_perm:[2,3,0,1] row_mask:0xf bank_mask:0xf
    v_add_f32_dpp v36, v36, v36 quad_perm:[2,3,0,1] row_mask:0xf bank_mask:0xf
    v_add_f32_dpp v38, v38, v38 quad_perm:[2,3,0,1] row_mask:0xf bank_mask:0xf
    s_nop 0
    v_add_f32_dpp v32, v32, v32 row_half_mirror row_mask:0xf bank_mask:0xf
    v_add_f32_dpp v34, v34, v34 row_half_mirror row_mask:0xf bank_mask:0xf
    v_add_f32_dpp v36, v36, v36 row_half_mirror row_mask:0xf bank_mask:0xf
    v_add_f32_dpp v38, v38, v38 row_half_mirror row_mask:0xf bank_mask:0xf
    s_nop 0
    v_add_f32_dpp v32, v32, v32 row_mirror row_mask:0xf bank_mask:0xf
    v_add_f32_dpp v34, v34, v34 row_mirror row_mask:0xf bank_mask:0xf
    v_add_f32_dpp v36, v36, v36 row_mirror row_mask:0xf bank_mask:0xf
    v_add_f32_dpp v38, v38, v38 row_mirror row_mask:0xf bank_mask:0xf
    v_mul_f32 v32, 0x3a800000, v32
    v_mul_f32 v34, 0x3a800000, v34
    v_fma_f32 v34, -v32, v32, v34
    v_max_f32 v34, 0, v34
    v_cvt_pk_bf16_f32 v34, v34, v34
    v_and_b32 v34, 0xffff0000, v34
    v_add_f32 v34, 0x3727c5ac, v34
    v_cvt_pk_bf16_f32 v34, v34, v34
    v_and_b32 v34, 0xffff0000, v34
    v_sqrt_f32 v34, v34
    s_nop 0
    v_cvt_pk_bf16_f32 v34, v34, v34
    v_and_b32 v34, 0xffff0000, v34
    v_cvt_pk_bf16_f32 v32, v32, v32
    v_and_b32 v32, 0xffff0000, v32
    v_rcp_f32 v33, v34
    v_fma_f32 v36, -v32, v38, v36
    v_mul_f32 v36, v36, v33
    v_cvt_pk_bf16_f32 v36, v36, v36
    v_and_b32 v36, 0xffff0000, v36
    v_ashrrev_i32 v35, 31, v36
    v_or_b32 v35, 0x80000000, v35
    v_xor_b32 v36, v36, v35
    v_and_b32 v36, 0xffff0000, v36
    v_lshrrev_b32 v35, 5, v1
    v_add_u32 v35, s50, v35
    v_sub_u32 v37, 0xffff, v35
    v_or_b32 v36, v36, v37
    v_or_b32 v32, 1, v32
    v_or_b32 v33, 1, v33
    v_lshlrev_b32 v37, 2, v35
    v_lshlrev_b32 v35, 3, v35
    s_mov_b32 s35, 270336
    s_mov_b32 s51, 286720
    s_mov_b32 exec_lo, 1
    s_mov_b32 exec_hi, 1
    buffer_store_dwordx2 v[32:33], v35, s[24:27], s35 offen sc1
    buffer_store_dword v36, v37, s[24:27], s51 offen sc1
    s_mov_b64 exec, -1
L_g_59:
    s_barrier
    s_barrier
    s_barrier
    s_barrier
    s_cmp_eq_u32 s34, 2
    s_cbranch_scc0 L_g_60
    s_mul_i32 s35, s33, 12288
    s_add_u32 s35, s35, 294912
    s_mov_b32 exec_hi, 0xffff
    buffer_load_dwordx4 v[40:43], v2, s[24:27], s35 offen sc1
    s_add_u32 s35, s35, 768
    buffer_load_dwordx4 v[44:47], v2, s[24:27], s35 offen sc1
    s_add_u32 s35, s35, 768
    buffer_load_dwordx4 v[48:51], v2, s[24:27], s35 offen sc1
    s_add_u32 s35, s35, 768
    buffer_load_dwordx4 v[52:55], v2, s[24:27], s35 offen sc1
    s_add_u32 s35, s35, 768
    buffer_load_dwordx4 v[56:59], v2, s[24:27], s35 offen sc1
    s_add_u32 s35, s35, 768
    buffer_load_dwordx4 v[60:63], v2, s[24:27], s35 offen sc1
    s_add_u32 s35, s35, 768
    buffer_load_dwordx4 v[64:67], v2, s[24:27], s35 offen sc1
    s_add_u32 s35, s35, 768
    buffer_load_dwordx4 v[68:71], v2, s[24:27], s35 offen sc1
    s_add_u32 s35, s35, 768
    buffer_load_dwordx4 v[72:75], v2, s[24:27], s35 offen sc1
    s_add_u32 s35, s35, 768
    buffer_load_dwordx4 v[76:79], v2, s[24:27], s35 offen sc1
    s_add_u32 s35, s35, 768
    buffer_load_dwordx4 v[80:83], v2, s[24:27], s35 offen sc1
    s_add_u32 s35, s35, 768
    buffer_load_dwordx4 v[84:87], v2, s[24:27], s35 offen sc1
    s_add_u32 s35, s35, 768
    buffer_load_dwordx4 v[88:91], v2, s[24:27], s35 offen sc1
    s_add_u32 s35, s35, 768
    buffer_load_dwordx4 v[92:95], v2, s[24:27], s35 offen sc1
    s_add_u32 s35, s35, 768
    buffer_load_dwordx4 v[96:99], v2, s[24:27], s35 offen sc1
    s_add_u32 s35, s35, 768
    buffer_load_dwordx4 v[100:103], v2, s[24:27], s35 offen sc1
    s_add_u32 s35, s35, 768
    s_mov_b64 exec, -1
L_g_60:
    s_cmp_eq_u32 s34, 3
    s_cbranch_scc0 L_g_61
    s_lshl_b32 s35, s32, 10
    s_add_u32 s35, s35, 270336
    buffer_load_dwordx4 v[40:43], v2, s[24:27], s35 offen sc1
L_g_61:
    s_barrier
    s_barrier
    s_cmp_eq_u32 s34, 2
    s_cbranch_scc0 L_g_64
    s_mov_b32 s61, 262144
L_rt_62:
    s_waitcnt vmcnt(0)
    v_min3_u32 v24, v40, v41, v42
    v_min3_u32 v24, v24, v43, v44
    v_min3_u32 v24, v24, v45, v46
    v_min3_u32 v24, v24, v47, v48
    v_min3_u32 v24, v24, v49, v50
    v_min3_u32 v24, v24, v51, v52
    v_min3_u32 v24, v24, v53, v54
    v_min3_u32 v24, v24, v55, v56
    v_min3_u32 v24, v24, v57, v58
    v_min3_u32 v24, v24, v59, v60
    v_min3_u32 v24, v24, v61, v62
    v_min3_u32 v24, v24, v63, v64
    v_min3_u32 v24, v24, v65, v66
    v_min3_u32 v24, v24, v67, v68
    v_min3_u32 v24, v24, v69, v70
    v_min3_u32 v24, v24, v71, v72
    v_min3_u32 v24, v24, v73, v74
    v_min3_u32 v24, v24, v75, v76
    v_min3_u32 v24, v24, v77, v78
    v_min3_u32 v24, v24, v79, v80
    v_min3_u32 v24, v24, v81, v82
    v_min3_u32 v24, v24, v83, v84
    v_min3_u32 v24, v24, v85, v86
    v_min3_u32 v24, v24, v87, v88
    v_min3_u32 v24, v24, v89, v90
    v_min3_u32 v24, v24, v91, v92
    v_min3_u32 v24, v24, v93, v94
    v_min3_u32 v24, v24, v95, v96
    v_min3_u32 v24, v24, v97, v98
    v_min3_u32 v24, v24, v99, v100
    v_min3_u32 v24, v24, v101, v102
    v_min_u32 v24, v24, v103
    v_cmp_eq_u32 vcc, 0, v24
    s_nop 1
    s_and_b32 vcc_hi, vcc_hi, 0xffff
    s_cmp_eq_u64 vcc, 0
    s_cbranch_scc1 L_rte_63
    s_sleep 8
    s_mul_i32 s35, s33, 12288
    s_add_u32 s35, s35, 294912
    s_mov_b32 exec_hi, 0xffff
    buffer_load_dwordx4 v[40:43], v2, s[24:27], s35 offen sc1
    s_add_u32 s35, s35, 768
    buffer_load_dwordx4 v[44:47], v2, s[24:27], s35 offen sc1
    s_add_u32 s35, s35, 768
    buffer_load_dwordx4 v[48:51], v2, s[24:27], s35 offen sc1
    s_add_u32 s35, s35, 768
    buffer_load_dwordx4 v[52:55], v2, s[24:27], s35 offen sc1
    s_add_u32 s35, s35, 768
    buffer_load_dwordx4 v[56:59], v2, s[24:27], s35 offen sc1
    s_add_u32 s35, s35, 768
    buffer_load_dwordx4 v[60:63], v2, s[24:27], s35 offen sc1
    s_add_u32 s35, s35, 768
    buffer_load_dwordx4 v[64:67], v2, s[24:27], s35 offen sc1
    s_add_u32 s35, s35, 768
    buffer_load_dwordx4 v[68:71], v2, s[24:27], s35 offen sc1
    s_add_u32 s35, s35, 768
    buffer_load_dwordx4 v[72:75], v2, s[24:27], s35 offen sc1
    s_add_u32 s35, s35, 768
    buffer_load_dwordx4 v[76:79], v2, s[24:27], s35 offen sc1
    s_add_u32 s35, s35, 768
    buffer_load_dwordx4 v[80:83], v2, s[24:27], s35 offen sc1
    s_add_u32 s35, s35, 768
    buffer_load_dwordx4 v[84:87], v2, s[24:27], s35 offen sc1
    s_add_u32 s35, s35, 768
    buffer_load_dwordx4 v[88:91], v2, s[24:27], s35 offen sc1
    s_add_u32 s35, s35, 768
    buffer_load_dwordx4 v[92:95], v2, s[24:27], s35 offen sc1
    s_add_u32 s35, s35, 768
    buffer_load_dwordx4 v[96:99], v2, s[24:27], s35 offen sc1
    s_add_u32 s35, s35, 768
    buffer_load_dwordx4 v[100:103], v2, s[24:27], s35 offen sc1
    s_add_u32 s35, s35, 768
    s_mov_b64 exec, -1
    s_sub_u32 s61, s61, 1
    s_cmp_lg_u32 s61, 0
    s_cbranch_scc1 L_rt_62
    s_waitcnt vmcnt(0)
L_rte_63:
L_g_64:
    s_cmp_eq_u32 s34, 3
    s_cbranch_scc0 L_g_67
    s_mov_b32 s61, 262144
L_rt_65:
    s_waitcnt vmcnt(0)
    v_min3_u32 v24, v40, v41, v42
    v_min_u32 v24, v24, v43
    v_cmp_eq_u32 vcc, 0, v24
    s_nop 1
    s_cmp_eq_u64 vcc, 0
    s_cbranch_scc1 L_rte_66
    s_sleep 8
    s_lshl_b32 s35, s32, 10
    s_add_u32 s35, s35, 270336
    buffer_load_dwordx4 v[40:43], v2, s[24:27], s35 offen sc1
    s_sub_u32 s61, s61, 1
    s_cmp_lg_u32 s61, 0
    s_cbranch_scc1 L_rt_65
    s_waitcnt vmcnt(0)
L_rte_66:
    v_mul_f32 v44, v40, v41
    v_mul_f32 v45, v42, v43
    v_mov_b32 v42, v41
    v_lshlrev_b32 v3, 3, v1
    v_add_u32 v3, 139264, v3
    ds_write_b64 v3, v[42:43]
    ds_write_b64 v3, v[44:45] offset:512
    s_waitcnt lgkmcnt(0)
L_g_67:
    s_barrier
    s_cmp_eq_u32 s34, 2
    s_cbranch_scc0 L_g_68
    v_add_f32 v40, v40, v44
    v_add_f32 v41, v41, v45
    v_add_f32 v42, v42, v46
    v_add_f32 v43, v43, v47
    v_add_f32 v40, v40, v48
    v_add_f32 v41, v41, v49
    v_add_f32 v42, v42, v50
    v_add_f32 v43, v43, v51
    v_add_f32 v40, v40, v52
    v_add_f32 v41, v41, v53
    v_add_f32 v42, v42, v54
    v_add_f32 v43, v43, v55
    v_add_f32 v40, v40, v56
    v_add_f32 v41, v41, v57
    v_add_f32 v42, v42, v58
    v_add_f32 v43, v43, v59
    v_add_f32 v40, v40, v60
    v_add_f32 v41, v41, v61
    v_add_f32 v42, v42, v62
    v_add_f32 v43, v43, v63
    v_add_f32 v40, v40, v64
    v_add_f32 v41, v41, v65
    v_add_f32 v42, v42, v66
    v_add_f32 v43, v43, v67
    v_add_f32 v40, v40, v68
    v_add_f32 v41, v41, v69
    v_add_f32 v42, v42, v70
    v_add_f32 v43, v43, v71
    v_add_f32 v40, v40, v72
    v_add_f32 v41, v41, v73
    v_add_f32 v42, v42, v74
    v_add_f32 v43, v43, v75
    v_add_f32 v40, v40, v76
    v_add_f32 v41, v41, v77
    v_add_f32 v42, v42, v78
    v_add_f32 v43, v43, v79
    v_add_f32 v40, v40, v80
    v_add_f32 v41, v41, v81
    v_add_f32 v42, v42, v82
    v_add_f32 v43, v43, v83
    v_add_f32 v40, v40, v84
    v_add_f32 v41, v41, v85
    v_add_f32 v42, v42, v86
    v_add_f32 v43, v43, v87
    v_add_f32 v40, v40, v88
    v_add_f32 v41, v41, v89
    v_add_f32 v42, v42, v90
    v_add_f32 v43, v43, v91
    v_add_f32 v40, v40, v92
    v_add_f32 v41, v41, v93
    v_add_f32 v42, v42, v94
    v_add_f32 v43, v43, v95
    v_add_f32 v40, v40, v96
    v_add_f32 v41, v41, v97
    v_add_f32 v42, v42, v98
    v_add_f32 v43, v43, v99
    v_add_f32 v40, v40, v100
    v_add_f32 v41, v41, v101
    v_add_f32 v42, v42, v102
    v_add_f32 v43, v43, v103
    v_add_u32 v3, 140288, v2
    s_mov_b32 exec_hi, 0xffff
    ds_write_b128 v3, v[40:43]
    s_mov_b64 exec, -1
    s_waitcnt lgkmcnt(0)
L_g_68:
    s_barrier
    s_load_dwordx4 s[52:55], s[0:1], 40
    s_load_dwordx2 s[56:57], s[0:1], 56
    s_load_dwordx2 s[58:59], s[0:1], 16
    s_add_u32 s24, s46, 20971520
    s_addc_u32 s25, s47, 0
    s_mov_b32 s26, 1048576
    s_mov_b32 s27, 0x20000
    s_mov_b32 s36, s4
    s_mov_b32 s37, s5
    s_mov_b32 s38, 4194304
    s_mov_b32 s39, 0x20000
    s_and_b32 s30, s2, 7
    s_lshr_b32 s31, s2, 3
    s_lshr_b32 s32, s30, 1
    s_lshl_b32 s32, s32, 2
    s_and_b32 s33, s31, 3
    s_add_u32 s32, s32, s33
    s_and_b32 s33, s30, 1
    s_lshl_b32 s33, s33, 3
    s_lshr_b32 s34, s31, 2
    s_add_u32 s33, s33, s34
    v_lshrrev_b32 v120, 3, v1
    v_lshlrev_b32 v120, 11, v120
    v_and_b32 v12, 7, v1
    v_bfe_u32 v15, v1, 4, 1
    v_lshlrev_b32 v15, 2, v15
    v_xor_b32 v12, v12, v15
    v_lshl_add_u32 v120, v12, 4, v120
    s_lshl_b32 s35, s33, 7
    v_add_u32 v120, s35, v120
    v_add_u32 v121, 15360, v120
    v_add_u32 v122, 30720, v120
    v_add_u32 v123, 46080, v120
    s_mov_b32 s63, s33
    s_mov_b32 s62, s32
    v_mov_b32 v2, 64516
    v_mov_b32 v3, 1
    s_sub_u32 s34, s22, 8
    s_lshr_b32 s48, s2, 2
    s_and_b32 s32, s2, 3
    s_lshr_b32 s33, s2, 4
    s_and_b32 s40, s2, 15
    s_lshl_b32 s23, s34, 13
    s_add_u32 s23, s23, 65536
    s_lshl_b32 s50, s34, 12
    s_lshl_b32 s51, s34, 16
    s_waitcnt lgkmcnt(0)
    s_mov_b32 s8, s52
    s_mov_b32 s9, s53
    s_mov_b32 s10, 7340032
    s_mov_b32 s11, 0x20000
    s_mov_b32 s12, s54
    s_mov_b32 s13, s55
    s_mov_b32 s14, 7340032
    s_mov_b32 s15, 0x20000
    s_mov_b32 s16, s56
    s_mov_b32 s17, s57
    s_mov_b32 s18, 7340032
    s_mov_b32 s19, 0x20000
    s_mov_b32 s28, s58
    s_mov_b32 s29, s59
    s_mov_b32 s30, 2097152
    s_mov_b32 s31, 0x20000
    s_cmp_ge_u32 s2, 224
    s_cbranch_scc1 L_moe_skip
    v_and_b32 v4, 7, v1
    v_lshlrev_b32 v21, 2, v4
    v_lshrrev_b32 v4, 3, v1
    v_bfe_u32 v5, v1, 4, 1
    v_lshlrev_b32 v5, 1, v5
    v_and_b32 v12, 7, v1
    v_xor_b32 v12, v12, v5
    v_xor_b32 v13, 4, v12
    s_lshl_b32 s35, s32, 8
    s_lshl_b32 s41, s34, 6
    s_add_u32 s35, s35, s41
    v_add_u32 v5, s35, v4
    v_mul_u32_u24 v5, 7168, v5
    s_lshl_b32 s35, s48, 7
    v_add_u32 v5, s35, v5
    v_lshl_add_u32 v8, v12, 4, v5
    v_lshl_add_u32 v9, v13, 4, v5
    v_add_u32 v10, 112640, v8
    v_add_u32 v11, 168960, v9
    v_add_u32 v9, 56320, v9
    s_lshl_b32 s35, s33, 8
    s_add_u32 s35, s35, s41
    v_add_u32 v5, s35, v4
    v_lshlrev_b32 v5, 11, v5
    s_lshl_b32 s35, s40, 7
    v_add_u32 v5, s35, v5
    v_lshl_add_u32 v112, v12, 4, v5
    v_lshl_add_u32 v113, v13, 4, v5
    v_add_u32 v114, 30720, v112
    v_add_u32 v115, 46080, v113
    v_add_u32 v113, 15360, v113
    v_lshrrev_b32 v5, 4, v1
    v_bfe_u32 v7, v1, 2, 2
    v_lshrrev_b32 v12, 1, v7
    v_and_b32 v13, 1, v5
    v_lshl_or_b32 v12, v13, 1, v12
    v_lshl_add_u32 v7, v5, 3, v7
    v_lshlrev_b32 v7, 7, v7
    v_and_b32 v13, 3, v1
    v_lshl_add_u32 v7, v13, 3, v7
    v_add_u32 v7, s23, v7
    v_xor_b32 v13, 0, v12
    v_lshl_add_u32 v116, v13, 5, v7
    v_xor_b32 v13, 1, v12
    v_lshl_add_u32 v117, v13, 5, v7
    v_xor_b32 v13, 2, v12
    v_lshl_add_u32 v118, v13, 5, v7
    v_xor_b32 v13, 3, v12
    v_lshl_add_u32 v119, v13, 5, v7
    v_lshl_add_u32 v13, v1, 4, s23
    s_lshr_b32 s35, s34, 1
    s_lshl_b32 s35, s35, 10
    s_and_b32 s41, s34, 1
    s_lshl_b32 s41, s41, 9
    s_add_u32 s35, s35, s41
    s_add_u32 s35, s35, 65536
    v_bfe_u32 v4, v1, 2, 1
    v_lshlrev_b32 v108, 8, v4
    v_lshrrev_b32 v4, 3, v1
    v_lshl_add_u32 v108, v4, 4, v108
    v_and_b32 v4, 3, v1
    v_lshl_add_u32 v108, v4, 2, v108
    v_add_u32 v108, s35, v108
    v_lshrrev_b32 v4, 4, v1
    v_lshlrev_b32 v109, 10, v4
    v_bfe_u32 v4, v1, 2, 2
    v_lshl_add_u32 v109, v4, 8, v109
    v_and_b32 v4, 3, v1
    v_lshl_add_u32 v109, v4, 2, v109
    s_lshl_b32 s35, s34, 5
    s_add_u32 s35, s35, 65536
    v_add_u32 v109, s35, v109
    v_and_b32 v4, 7, v1
    v_lshl_add_u32 v4, v5, 3, v4
    v_lshlrev_b32 v110, 5, v4
    v_bfe_u32 v4, v1, 3, 1
    v_lshl_add_u32 v110, v4, 10, v110
    v_lshlrev_b32 v111, 2, v1
    s_lshl_b32 s42, s48, 12
    s_lshl_b32 s41, s34, 8
    s_add_u32 s42, s42, s41
    s_add_u32 s42, s42, 0
    s_lshl_b32 s43, s33, 2
    s_add_u32 s43, s43, s34
    s_lshl_b32 s43, s43, 12
    s_add_u32 s43, s43, 0
    s_lshl_b32 s52, s34, 13
    s_lshl_b32 s41, s40, 8
    s_add_u32 s52, s52, s41
    s_add_u32 s52, s52, 229376
    s_add_u32 s53, s52, 4096
    s_add_u32 s54, s41, 266240
    s_lshl_b32 s55, s33, 8
    s_add_u32 s55, s55, 262656
    s_barrier
    v_mov_b32 v6, 64512
    s_mov_b32 s61, 1048576
L_lw_69:
    ds_read_b32 v4, v6
    s_waitcnt lgkmcnt(0)
    v_cmp_gt_u32 vcc, 16, v4
    s_cbranch_vccz L_lwe_70
    s_sleep 4
    s_sub_u32 s61, s61, 1
    s_cmp_lg_u32 s61, 0
    s_cbranch_scc1 L_lw_69
L_lwe_70:
    s_mov_b32 s41, 262144
    buffer_load_dword v20, v21, s[24:27], s41 offen sc1
    s_add_u32 m0, s23, 0
    s_mov_b32 s35, 0
    buffer_load_dwordx4 v8, s[8:11], s35 offen offset:0 lds
    buffer_load_dwordx4 v9, s[8:11], s35 offen offset:1024 lds
    buffer_load_dwordx4 v10, s[8:11], s35 offen offset:2048 lds
    buffer_load_dwordx4 v11, s[8:11], s35 offen offset:3072 lds
    s_waitcnt vmcnt(3)
    s_add_u32 m0, s23, 4096
    s_mov_b32 s35, 229376
    buffer_load_dwordx4 v8, s[8:11], s35 offen offset:0 lds
    s_waitcnt vmcnt(3)
    buffer_load_dwordx4 v9, s[8:11], s35 offen offset:1024 lds
    s_waitcnt vmcnt(3)
    buffer_load_dwordx4 v10, s[8:11], s35 offen offset:2048 lds
    s_waitcnt vmcnt(3)
    buffer_load_dwordx4 v11, s[8:11], s35 offen offset:3072 lds
    s_mov_b32 s61, 262144
L_rt_71:
    s_waitcnt vmcnt(0)
    v_cmp_eq_u32 vcc, 0, v20
    s_nop 1
    s_cmp_eq_u64 vcc, 0
    s_cbranch_scc1 L_rte_72
    s_sleep 8
    buffer_load_dword v20, v21, s[24:27], s41 offen sc1
    s_sub_u32 s61, s61, 1
    s_cmp_lg_u32 s61, 0
    s_cbranch_scc1 L_rt_71
    s_waitcnt vmcnt(0)
L_rte_72:
    s_setprio 3
    v_add_u32 v20, -1, v20
    v_lshlrev_b32 v12, 11, v20
    v_lshl_add_u32 v12, v5, 4, v12
    v_lshlrev_b32 v20, 3, v20
    s_lshl_b32 s35, s32, 9
    s_lshl_b32 s41, s34, 7
    s_add_u32 s35, s35, s41
    s_mov_b32 s41, 270336
    buffer_load_dwordx4 v[16:19], v12, s[36:39], s35 offen
    buffer_load_dwordx4 v[24:27], v12, s[36:39], s35 offen offset:64
    buffer_load_dwordx2 v[22:23], v20, s[24:27], s41 offen sc1
    s_setprio 0
    s_mov_b32 s61, 262144
L_rt_73:
    s_waitcnt vmcnt(0)
    v_min_u32 v14, v22, v23
    v_cmp_eq_u32 vcc, 0, v14
    s_nop 1
    s_cmp_eq_u64 vcc, 0
    s_cbranch_scc1 L_rte_74
    s_sleep 8
    buffer_load_dwordx2 v[22:23], v20, s[24:27], s41 offen sc1
    s_sub_u32 s61, s61, 1
    s_cmp_lg_u32 s61, 0
    s_cbranch_scc1 L_rt_73
    s_waitcnt vmcnt(0)
L_rte_74:
    s_setprio 3
    v_mul_f32 v22, v22, v23
    v_sub_f32 v22, 0, v22
    v_lshlrev_b32 v14, 16, v16
    v_and_b32 v15, 0xffff0000, v16
    v_fma_f32 v14, v14, v23, v22
    v_fma_f32 v15, v15, v23, v22
    v_cvt_pk_bf16_f32 v16, v14, v15
    v_lshlrev_b32 v14, 16, v17
    v_and_b32 v15, 0xffff0000, v17
    v_fma_f32 v14, v14, v23, v22
    v_fma_f32 v15, v15, v23, v22
    v_cvt_pk_bf16_f32 v17, v14, v15
    v_lshlrev_b32 v14, 16, v18
    v_and_b32 v15, 0xffff0000, v18
    v_fma_f32 v14, v14, v23, v22
    v_fma_f32 v15, v15, v23, v22
    v_cvt_pk_bf16_f32 v18, v14, v15
    v_lshlrev_b32 v14, 16, v19
    v_and_b32 v15, 0xffff0000, v19
    v_fma_f32 v14, v14, v23, v22
    v_fma_f32 v15, v15, v23, v22
    v_cvt_pk_bf16_f32 v19, v14, v15
    v_lshlrev_b32 v14, 16, v24
    v_and_b32 v15, 0xffff0000, v24
    v_fma_f32 v14, v14, v23, v22
    v_fma_f32 v15, v15, v23, v22
    v_cvt_pk_bf16_f32 v24, v14, v15
    v_lshlrev_b32 v14, 16, v25
    v_and_b32 v15, 0xffff0000, v25
    v_fma_f32 v14, v14, v23, v22
    v_fma_f32 v15, v15, v23, v22
    v_cvt_pk_bf16_f32 v25, v14, v15
    v_lshlrev_b32 v14, 16, v26
    v_and_b32 v15, 0xffff0000, v26
    v_fma_f32 v14, v14, v23, v22
    v_fma_f32 v15, v15, v23, v22
    v_cvt_pk_bf16_f32 v26, v14, v15
    v_lshlrev_b32 v14, 16, v27
    v_and_b32 v15, 0xffff0000, v27
    v_fma_f32 v14, v14, v23, v22
    v_fma_f32 v15, v15, v23, v22
    v_cvt_pk_bf16_f32 v27, v14, v15
    s_setprio 0
    ds_read_b64_tr_b16 v[76:77], v116 offset:0
    ds_read_b64_tr_b16 v[78:79], v116 offset:512
    ds_read_b64_tr_b16 v[80:81], v117 offset:0
    ds_read_b64_tr_b16 v[82:83], v117 offset:512
    ds_read_b64_tr_b16 v[84:85], v118 offset:0
    ds_read_b64_tr_b16 v[86:87], v118 offset:512
    ds_read_b64_tr_b16 v[88:89], v119 offset:0
    ds_read_b64_tr_b16 v[90:91], v119 offset:512
    s_waitcnt lgkmcnt(4)
    ds_read_b64_tr_b16 v[92:93], v116 offset:4096
    ds_read_b64_tr_b16 v[94:95], v116 offset:4608
    ds_read_b64_tr_b16 v[96:97], v117 offset:4096
    ds_read_b64_tr_b16 v[98:99], v117 offset:4608
    ds_read_b64_tr_b16 v[100:101], v118 offset:4096
    ds_read_b64_tr_b16 v[102:103], v118 offset:4608
    ds_read_b64_tr_b16 v[104:105], v119 offset:4096
    ds_read_b64_tr_b16 v[106:107], v119 offset:4608
    s_waitcnt lgkmcnt(0)
    v_mfma_f32_16x16x32_bf16 v[32:35], v[76:79], v[16:19], 0
    v_mfma_f32_16x16x32_bf16 v[36:39], v[80:83], v[16:19], 0
    v_mfma_f32_16x16x32_bf16 v[40:43], v[84:87], v[16:19], 0
    v_mfma_f32_16x16x32_bf16 v[44:47], v[88:91], v[16:19], 0
    v_mfma_f32_16x16x32_bf16 v[32:35], v[92:95], v[24:27], v[32:35]
    v_mfma_f32_16x16x32_bf16 v[36:39], v[96:99], v[24:27], v[36:39]
    v_mfma_f32_16x16x32_bf16 v[40:43], v[100:103], v[24:27], v[40:43]
    v_mfma_f32_16x16x32_bf16 v[44:47], v[104:107], v[24:27], v[44:47]
    s_add_u32 m0, s23, 0
    s_mov_b32 s35, 0
    buffer_load_dwordx4 v8, s[12:15], s35 offen offset:0 lds
    buffer_load_dwordx4 v9, s[12:15], s35 offen offset:1024 lds
    buffer_load_dwordx4 v10, s[12:15], s35 offen offset:2048 lds
    buffer_load_dwordx4 v11, s[12:15], s35 offen offset:3072 lds
    s_waitcnt vmcnt(3)
    s_add_u32 m0, s23, 4096
    s_mov_b32 s35, 229376
    buffer_load_dwordx4 v8, s[12:15], s35 offen offset:0 lds
    s_waitcnt vmcnt(3)
    buffer_load_dwordx4 v9, s[12:15], s35 offen offset:1024 lds
    s_waitcnt vmcnt(3)
    buffer_load_dwordx4 v10, s[12:15], s35 offen offset:2048 lds
    s_waitcnt vmcnt(3)
    buffer_load_dwordx4 v11, s[12:15], s35 offen offset:3072 lds
    s_waitcnt vmcnt(0)
    s_add_u32 m0, s50, 0
    s_add_u32 s35, s51, 0
    buffer_load_dwordx4 v120, s[28:31], s35 offen offset:0 lds
    buffer_load_dwordx4 v121, s[28:31], s35 offen offset:1024 lds
    buffer_load_dwordx4 v122, s[28:31], s35 offen offset:2048 lds
    buffer_load_dwordx4 v123, s[28:31], s35 offen offset:3072 lds
    ds_read_b64_tr_b16 v[76:77], v116 offset:0
    ds_read_b64_tr_b16 v[78:79], v116 offset:512
    ds_read_b64_tr_b16 v[80:81], v117 offset:0
    ds_read_b64_tr_b16 v[82:83], v117 offset:512
    ds_read_b64_tr_b16 v[84:85], v118 offset:0
    ds_read_b64_tr_b16 v[86:87], v118 offset:512
    ds_read_b64_tr_b16 v[88:89], v119 offset:0
    ds_read_b64_tr_b16 v[90:91], v119 offset:512
    s_waitcnt lgkmcnt(4)
    ds_read_b64_tr_b16 v[92:93], v116 offset:4096
    ds_read_b64_tr_b16 v[94:95], v116 offset:4608
    ds_read_b64_tr_b16 v[96:97], v117 offset:4096
    ds_read_b64_tr_b16 v[98:99], v117 offset:4608
    ds_read_b64_tr_b16 v[100:101], v118 offset:4096
    ds_read_b64_tr_b16 v[102:103], v118 offset:4608
    ds_read_b64_tr_b16 v[104:105], v119 offset:4096
    ds_read_b64_tr_b16 v[106:107], v119 offset:4608
    s_waitcnt lgkmcnt(0)
    v_mfma_f32_16x16x32_bf16 v[48:51], v[76:79], v[16:19], 0
    v_mfma_f32_16x16x32_bf16 v[52:55], v[80:83], v[16:19], 0
    v_mfma_f32_16x16x32_bf16 v[56:59], v[84:87], v[16:19], 0
    v_mfma_f32_16x16x32_bf16 v[60:63], v[88:91], v[16:19], 0
    v_mfma_f32_16x16x32_bf16 v[48:51], v[92:95], v[24:27], v[48:51]
    v_mfma_f32_16x16x32_bf16 v[52:55], v[96:99], v[24:27], v[52:55]
    v_mfma_f32_16x16x32_bf16 v[56:59], v[100:103], v[24:27], v[56:59]
    v_mfma_f32_16x16x32_bf16 v[60:63], v[104:107], v[24:27], v[60:63]
    s_nop 7
    ds_write_b128 v13, v[32:35] offset:0
    ds_write_b128 v13, v[36:39] offset:1024
    ds_write_b128 v13, v[40:43] offset:2048
    ds_write_b128 v13, v[44:47] offset:3072
    ds_write_b128 v13, v[48:51] offset:4096
    ds_write_b128 v13, v[52:55] offset:5120
    ds_write_b128 v13, v[56:59] offset:6144
    ds_write_b128 v13, v[60:63] offset:7168
    s_waitcnt lgkmcnt(0)
    s_mov_b64 exec, 1
    ds_add_u32 v2, v3
    s_mov_b64 exec, -1
    s_mov_b32 s61, 1048576
L_lw_75:
    ds_read_b32 v4, v2
    s_waitcnt lgkmcnt(0)
    v_cmp_gt_u32 vcc, 4, v4
    s_cbranch_vccz L_lwe_76
    s_sleep 5
    s_sub_u32 s61, s61, 1
    s_cmp_lg_u32 s61, 0
    s_cbranch_scc1 L_lw_75
L_lwe_76:
    ds_read_b32 v32, v108 offset:0
    ds_read_b32 v33, v108 offset:8192
    ds_read_b32 v34, v108 offset:16384
    ds_read_b32 v35, v108 offset:24576
    ds_read_b32 v36, v108 offset:2048
    ds_read_b32 v37, v108 offset:10240
    ds_read_b32 v38, v108 offset:18432
    ds_read_b32 v39, v108 offset:26624
    s_waitcnt lgkmcnt(0)
    ds_read_b32 v40, v108 offset:4096
    ds_read_b32 v41, v108 offset:12288
    ds_read_b32 v42, v108 offset:20480
    ds_read_b32 v43, v108 offset:28672
    ds_read_b32 v44, v108 offset:6144
    ds_read_b32 v45, v108 offset:14336
    ds_read_b32 v46, v108 offset:22528
    ds_read_b32 v47, v108 offset:30720
    s_waitcnt lgkmcnt(0)
    s_setprio 3
    v_add_f32 v32, v32, v33
    v_add_f32 v34, v34, v35
    v_add_f32 v32, v32, v34
    buffer_atomic_add_f32 v32, v111, s[24:27], s42 offen offset:0
    v_add_f32 v36, v36, v37
    v_add_f32 v38, v38, v39
    v_add_f32 v36, v36, v38
    buffer_atomic_add_f32 v36, v111, s[24:27], s42 offen offset:1024
    v_add_f32 v40, v40, v41
    v_add_f32 v42, v42, v43
    v_add_f32 v40, v40, v42
    buffer_atomic_add_f32 v40, v111, s[24:27], s42 offen offset:2048
    v_add_f32 v44, v44, v45
    v_add_f32 v46, v46, v47
    v_add_f32 v44, v44, v46
    buffer_atomic_add_f32 v44, v111, s[24:27], s42 offen offset:3072
    s_setprio 0
    s_waitcnt lgkmcnt(0)
    s_mov_b64 exec, 1
    ds_add_u32 v2, v3
    s_mov_b64 exec, -1
    s_mov_b32 s61, 1048576
L_lw_77:
    ds_read_b32 v4, v2
    s_waitcnt lgkmcnt(0)
    v_cmp_gt_u32 vcc, 8, v4
    s_cbranch_vccz L_lwe_78
    s_sleep 5
    s_sub_u32 s61, s61, 1
    s_cmp_lg_u32 s61, 0
    s_cbranch_scc1 L_lw_77
L_lwe_78:
    s_waitcnt vmcnt(0)
    s_mov_b64 exec, 1
    buffer_atomic_add v3, off, s[24:27], s55 sc1
    s_mov_b64 exec, -1
    s_add_u32 m0, s23, 0
    s_mov_b32 s35, 0
    buffer_load_dwordx4 v112, s[16:19], s35 offen offset:0 lds
    buffer_load_dwordx4 v113, s[16:19], s35 offen offset:1024 lds
    buffer_load_dwordx4 v114, s[16:19], s35 offen offset:2048 lds
    buffer_load_dwordx4 v115, s[16:19], s35 offen offset:3072 lds
    s_waitcnt vmcnt(3)
    s_add_u32 m0, s23, 4096
    s_mov_b32 s35, 65536
    buffer_load_dwordx4 v112, s[16:19], s35 offen offset:0 lds
    s_waitcnt vmcnt(3)
    buffer_load_dwordx4 v113, s[16:19], s35 offen offset:1024 lds
    s_waitcnt vmcnt(3)
    buffer_load_dwordx4 v114, s[16:19], s35 offen offset:2048 lds
    s_waitcnt vmcnt(3)
    buffer_load_dwordx4 v115, s[16:19], s35 offen offset:3072 lds
    s_add_u32 m0, s50, 16384
    s_add_u32 s35, s51, 262144
    buffer_load_dwordx4 v120, s[28:31], s35 offen offset:0 lds
    buffer_load_dwordx4 v121, s[28:31], s35 offen offset:1024 lds
    buffer_load_dwordx4 v122, s[28:31], s35 offen offset:2048 lds
    buffer_load_dwordx4 v123, s[28:31], s35 offen offset:3072 lds
    s_waitcnt vmcnt(4)
    s_cmp_lg_u32 s34, 0
    s_cbranch_scc1 L_moe_np
    s_mov_b32 s61, 262144
L_spin_79:
    buffer_load_dword v4, off, s[24:27], s55 sc1
    s_waitcnt vmcnt(0)
    v_readfirstlane_b32 s60, v4
    s_nop 0
    s_cmp_ge_u32 s60, 64
    s_cbranch_scc1 L_spun_80
    s_sleep 16
    s_sub_u32 s61, s61, 1
    s_cmp_lg_u32 s61, 0
    s_cbranch_scc1 L_spin_79
L_spun_80:
L_moe_np:
    s_waitcnt lgkmcnt(0)
    s_mov_b64 exec, 1
    ds_add_u32 v2, v3
    s_mov_b64 exec, -1
    s_mov_b32 s61, 1048576
L_lw_81:
    ds_read_b32 v4, v2
    s_waitcnt lgkmcnt(0)
    v_cmp_gt_u32 vcc, 12, v4
    s_cbranch_vccz L_lwe_82
    s_sleep 5
    s_sub_u32 s61, s61, 1
    s_cmp_lg_u32 s61, 0
    s_cbranch_scc1 L_lw_81
L_lwe_82:
    buffer_load_dwordx4 v[16:19], v110, s[24:27], s43 offen sc1
    buffer_load_dwordx4 v[20:23], v110, s[24:27], s43 offen offset:16 sc1
    buffer_load_dwordx4 v[24:27], v110, s[24:27], s43 offen offset:2048 sc1
    buffer_load_dwordx4 v[28:31], v110, s[24:27], s43 offen offset:2064 sc1
    s_waitcnt vmcnt(0)
    s_setprio 3
    v_mul_f32 v14, 0xbfb8aa3b, v16
    v_mul_f32 v15, 0xbfb8aa3b, v17
    v_exp_f32 v14, v14
    v_exp_f32 v15, v15
    v_mul_f32 v16, v16, v24
    v_add_f32 v14, 1.0, v14
    v_add_f32 v15, 1.0, v15
    v_rcp_f32 v14, v14
    v_rcp_f32 v15, v15
    v_mul_f32 v17, v17, v25
    v_mul_f32 v16, v16, v14
    v_mul_f32 v17, v17, v15
    v_cvt_pk_bf16_f32 v64, v16, v17
    v_mul_f32 v14, 0xbfb8aa3b, v18
    v_mul_f32 v15, 0xbfb8aa3b, v19
    v_exp_f32 v14, v14
    v_exp_f32 v15, v15
    v_mul_f32 v18, v18, v26
    v_add_f32 v14, 1.0, v14
    v_add_f32 v15, 1.0, v15
    v_rcp_f32 v14, v14
    v_rcp_f32 v15, v15
    v_mul_f32 v19, v19, v27
    v_mul_f32 v18, v18, v14
    v_mul_f32 v19, v19, v15
    v_cvt_pk_bf16_f32 v65, v18, v19
    v_mul_f32 v14, 0xbfb8aa3b, v20
    v_mul_f32 v15, 0xbfb8aa3b, v21
    v_exp_f32 v14, v14
    v_exp_f32 v15, v15
    v_mul_f32 v20, v20, v28
    v_add_f32 v14, 1.0, v14
    v_add_f32 v15, 1.0, v15
    v_rcp_f32 v14, v14
    v_rcp_f32 v15, v15
    v_mul_f32 v21, v21, v29
    v_mul_f32 v20, v20, v14
    v_mul_f32 v21, v21, v15
    v_cvt_pk_bf16_f32 v66, v20, v21
    v_mul_f32 v14, 0xbfb8aa3b, v22
    v_mul_f32 v15, 0xbfb8aa3b, v23
    v_exp_f32 v14, v14
    v_exp_f32 v15, v15
    v_mul_f32 v22, v22, v30
    v_add_f32 v14, 1.0, v14
    v_add_f32 v15, 1.0, v15
    v_rcp_f32 v14, v14
    v_rcp_f32 v15, v15
    v_mul_f32 v23, v23, v31
    v_mul_f32 v22, v22, v14
    v_mul_f32 v23, v23, v15
    v_cvt_pk_bf16_f32 v67, v22, v23
    s_setprio 0
    ds_read_b64_tr_b16 v[76:77], v116 offset:0
    ds_read_b64_tr_b16 v[78:79], v116 offset:512
    ds_read_b64_tr_b16 v[80:81], v117 offset:0
    ds_read_b64_tr_b16 v[82:83], v117 offset:512
    ds_read_b64_tr_b16 v[84:85], v118 offset:0
    ds_read_b64_tr_b16 v[86:87], v118 offset:512
    ds_read_b64_tr_b16 v[88:89], v119 offset:0
    ds_read_b64_tr_b16 v[90:91], v119 offset:512
    s_waitcnt lgkmcnt(4)
    ds_read_b64_tr_b16 v[92:93], v116 offset:4096
    ds_read_b64_tr_b16 v[94:95], v116 offset:4608
    ds_read_b64_tr_b16 v[96:97], v117 offset:4096
    ds_read_b64_tr_b16 v[98:99], v117 offset:4608
    ds_read_b64_tr_b16 v[100:101], v118 offset:4096
    ds_read_b64_tr_b16 v[102:103], v118 offset:4608
    ds_read_b64_tr_b16 v[104:105], v119 offset:4096
    ds_read_b64_tr_b16 v[106:107], v119 offset:4608
    s_waitcnt lgkmcnt(0)
    v_mfma_f32_16x16x32_bf16 v[32:35], v[76:79], v[64:67], 0
    v_mfma_f32_16x16x32_bf16 v[36:39], v[80:83], v[64:67], 0
    v_mfma_f32_16x16x32_bf16 v[40:43], v[84:87], v[64:67], 0
    v_mfma_f32_16x16x32_bf16 v[44:47], v[88:91], v[64:67], 0
    v_mfma_f32_16x16x32_bf16 v[48:51], v[92:95], v[64:67], 0
    v_mfma_f32_16x16x32_bf16 v[52:55], v[96:99], v[64:67], 0
    v_mfma_f32_16x16x32_bf16 v[56:59], v[100:103], v[64:67], 0
    v_mfma_f32_16x16x32_bf16 v[60:63], v[104:107], v[64:67], 0
    s_nop 7
    ds_write_b128 v13, v[32:35] offset:0
    ds_write_b128 v13, v[36:39] offset:1024
    ds_write_b128 v13, v[40:43] offset:2048
    ds_write_b128 v13, v[44:47] offset:3072
    ds_write_b128 v13, v[48:51] offset:4096
    ds_write_b128 v13, v[52:55] offset:5120
    ds_write_b128 v13, v[56:59] offset:6144
    ds_write_b128 v13, v[60:63] offset:7168
    s_waitcnt lgkmcnt(0)
    s_mov_b64 exec, 1
    ds_add_u32 v2, v3
    s_mov_b64 exec, -1
    s_mov_b32 s61, 1048576
L_lw_83:
    ds_read_b32 v4, v2
    s_waitcnt lgkmcnt(0)
    v_cmp_gt_u32 vcc, 16, v4
    s_cbranch_vccz L_lwe_84
    s_sleep 5
    s_sub_u32 s61, s61, 1
    s_cmp_lg_u32 s61, 0
    s_cbranch_scc1 L_lw_83
L_lwe_84:
    ds_read_b32 v32, v109 offset:0
    ds_read_b32 v33, v109 offset:4224
    ds_read_b32 v34, v109 offset:8192
    ds_read_b32 v35, v109 offset:12416
    ds_read_b32 v36, v109 offset:16384
    ds_read_b32 v37, v109 offset:20608
    ds_read_b32 v38, v109 offset:24576
    ds_read_b32 v39, v109 offset:28800
    s_waitcnt lgkmcnt(0)
    ds_read_b32 v40, v109 offset:16
    ds_read_b32 v41, v109 offset:4240
    ds_read_b32 v42, v109 offset:8208
    ds_read_b32 v43, v109 offset:12432
    ds_read_b32 v44, v109 offset:16400
    ds_read_b32 v45, v109 offset:20624
    ds_read_b32 v46, v109 offset:24592
    ds_read_b32 v47, v109 offset:28816
    s_waitcnt lgkmcnt(0)
    s_setprio 3
    v_add_f32 v32, v32, v33
    v_add_f32 v34, v34, v35
    v_add_f32 v36, v36, v37
    v_add_f32 v38, v38, v39
    v_add_f32 v32, v32, v34
    v_add_f32 v36, v36, v38
    v_add_f32 v32, v32, v36
    buffer_atomic_add_f32 v32, v111, s[24:27], s52 offen
    v_add_f32 v40, v40, v41
    v_add_f32 v42, v42, v43
    v_add_f32 v44, v44, v45
    v_add_f32 v46, v46, v47
    v_add_f32 v40, v40, v42
    v_add_f32 v44, v44, v46
    v_add_f32 v40, v40, v44
    buffer_atomic_add_f32 v40, v111, s[24:27], s53 offen
    s_setprio 0
    s_waitcnt lgkmcnt(0)
    s_mov_b64 exec, 1
    ds_add_u32 v2, v3
    s_mov_b64 exec, -1
    s_mov_b32 s61, 1048576
L_lw_85:
    ds_read_b32 v4, v2
    s_waitcnt lgkmcnt(0)
    v_cmp_gt_u32 vcc, 20, v4
    s_cbranch_vccz L_lwe_86
    s_sleep 5
    s_sub_u32 s61, s61, 1
    s_cmp_lg_u32 s61, 0
    s_cbranch_scc1 L_lw_85
L_lwe_86:
    s_waitcnt vmcnt(0)
    s_mov_b64 exec, 1
    buffer_atomic_add v3, off, s[24:27], s54 sc1
    s_mov_b64 exec, -1
    s_branch L_moe_join
L_moe_skip:
    s_barrier
    v_mov_b32 v6, 64512
    s_mov_b32 s61, 1048576
L_lw_87:
    ds_read_b32 v4, v6
    s_waitcnt lgkmcnt(0)
    v_cmp_gt_u32 vcc, 16, v4
    s_cbranch_vccz L_lwe_88
    s_sleep 4
    s_sub_u32 s61, s61, 1
    s_cmp_lg_u32 s61, 0
    s_cbranch_scc1 L_lw_87
L_lwe_88:
    s_add_u32 m0, s50, 0
    s_add_u32 s35, s51, 0
    buffer_load_dwordx4 v120, s[28:31], s35 offen offset:0 lds
    buffer_load_dwordx4 v121, s[28:31], s35 offen offset:1024 lds
    buffer_load_dwordx4 v122, s[28:31], s35 offen offset:2048 lds
    buffer_load_dwordx4 v123, s[28:31], s35 offen offset:3072 lds
    s_waitcnt vmcnt(4)
    s_add_u32 m0, s50, 16384
    s_add_u32 s35, s51, 262144
    buffer_load_dwordx4 v120, s[28:31], s35 offen offset:0 lds
    buffer_load_dwordx4 v121, s[28:31], s35 offen offset:1024 lds
    buffer_load_dwordx4 v122, s[28:31], s35 offen offset:2048 lds
    buffer_load_dwordx4 v123, s[28:31], s35 offen offset:3072 lds
    s_waitcnt vmcnt(4)
L_moe_join:
    s_add_u32 m0, s50, 32768
    s_add_u32 s35, s51, 524288
    buffer_load_dwordx4 v120, s[28:31], s35 offen offset:0 lds
    buffer_load_dwordx4 v121, s[28:31], s35 offen offset:1024 lds
    buffer_load_dwordx4 v122, s[28:31], s35 offen offset:2048 lds
    buffer_load_dwordx4 v123, s[28:31], s35 offen offset:3072 lds
    s_waitcnt vmcnt(4)
    s_add_u32 m0, s50, 49152
    s_add_u32 s35, s51, 786432
    buffer_load_dwordx4 v120, s[28:31], s35 offen offset:0 lds
    buffer_load_dwordx4 v121, s[28:31], s35 offen offset:1024 lds
    buffer_load_dwordx4 v122, s[28:31], s35 offen offset:2048 lds
    s_cmp_eq_u32 s34, 3
    s_cbranch_scc1 L_moe_w1
    buffer_load_dwordx4 v123, s[28:31], s35 offen offset:3072 lds
L_moe_w1:
    s_waitcnt vmcnt(4)
    s_add_u32 m0, s50, 65536
    s_add_u32 s35, s51, 1048576
    buffer_load_dwordx4 v120, s[28:31], s35 offen offset:0 lds
    buffer_load_dwordx4 v121, s[28:31], s35 offen offset:1024 lds
    buffer_load_dwordx4 v122, s[28:31], s35 offen offset:2048 lds
    buffer_load_dwordx4 v123, s[28:31], s35 offen offset:3072 lds
    s_waitcnt vmcnt(4)
    s_add_u32 m0, s50, 81920
    s_add_u32 s35, s51, 1310720
    buffer_load_dwordx4 v120, s[28:31], s35 offen offset:0 lds
    buffer_load_dwordx4 v121, s[28:31], s35 offen offset:1024 lds
    buffer_load_dwordx4 v122, s[28:31], s35 offen offset:2048 lds
    buffer_load_dwordx4 v123, s[28:31], s35 offen offset:3072 lds
    s_waitcnt vmcnt(4)
    s_add_u32 s35, s51, 1572864
    buffer_load_dwordx4 v[128:131], v120, s[28:31], s35 offen offset:0
    buffer_load_dwordx4 v[132:135], v121, s[28:31], s35 offen offset:1024
    buffer_load_dwordx4 v[136:139], v122, s[28:31], s35 offen offset:2048
    buffer_load_dwordx4 v[140:143], v123, s[28:31], s35 offen offset:3072
    s_waitcnt vmcnt(4)
    s_add_u32 s35, s51, 1835008
    buffer_load_dwordx4 v[144:147], v120, s[28:31], s35 offen offset:0
    buffer_load_dwordx4 v[148:151], v121, s[28:31], s35 offen offset:1024
    buffer_load_dwordx4 v[152:155], v122, s[28:31], s35 offen offset:2048
    buffer_load_dwordx4 v[156:159], v123, s[28:31], s35 offen offset:3072
    s_mov_b32 s35, 1032192
    buffer_load_dwordx4 v[160:163], v120, s[28:31], s35 offen
    v_lshlrev_b32 v9, 4, v1
    s_add_u32 s35, s50, 98304
    v_add_u32 v9, s35, v9
    s_waitcnt vmcnt(0)
    v_mov_b32 v6, 64512
    s_mov_b32 s61, 1048576
L_lw_89:
    ds_read_b32 v4, v6
    s_waitcnt lgkmcnt(0)
    v_cmp_gt_u32 vcc, 136, v4
    s_cbranch_vccz L_lwe_90
    s_sleep 12
    s_sub_u32 s61, s61, 1
    s_cmp_lg_u32 s61, 0
    s_cbranch_scc1 L_lw_89
L_lwe_90:
    s_setprio 3
    s_cmp_lg_u32 s34, 0
    s_cbranch_scc1 L_p3l_e
    s_lshl_b32 s41, s63, 8
    s_add_u32 s41, s41, 266240
    s_lshl_b32 s40, s62, 12
    s_add_u32 s40, s40, 688128
    v_lshrrev_b32 v8, 1, v1
    v_lshlrev_b32 v8, 7, v8
    v_and_b32 v10, 1, v1
    v_lshl_add_u32 v8, v10, 3, v8
    buffer_load_dwordx2 v[10:11], v8, s[24:27], s40 offen sc1
    buffer_load_dword v5, off, s[24:27], s41 sc1
L_p3l_e:
    ds_write_b128 v9, v[128:131] offset:0
    ds_write_b128 v9, v[132:135] offset:1024
    ds_write_b128 v9, v[136:139] offset:2048
    ds_write_b128 v9, v[140:143] offset:3072
    ds_write_b128 v9, v[144:147] offset:16384
    ds_write_b128 v9, v[148:151] offset:17408
    ds_write_b128 v9, v[152:155] offset:18432
    ds_write_b128 v9, v[156:159] offset:19456
    s_waitcnt lgkmcnt(0)
    s_mov_b64 exec, 1
    ds_add_u32 v2, v3
    s_mov_b64 exec, -1
    s_cmp_lg_u32 s34, 0
    s_cbranch_scc1 L_moe_done
    s_lshl_b32 s41, s63, 8
    s_add_u32 s41, s41, 266240
    s_lshl_b32 s40, s62, 12
    s_add_u32 s40, s40, 688128
    v_lshrrev_b32 v8, 1, v1
    v_lshlrev_b32 v8, 7, v8
    v_and_b32 v12, 1, v1
    v_lshl_add_u32 v8, v12, 3, v8
    s_cmp_ge_u32 s2, 224
    s_cselect_b32 s42, 4, 24
    s_mov_b32 s61, 1048576
L_lw_91:
    ds_read_b32 v4, v6
    s_waitcnt lgkmcnt(0)
    v_cmp_gt_u32 vcc, 144, v4
    s_cbranch_vccz L_lwe_92
    s_sleep 2
    s_sub_u32 s61, s61, 1
    s_cmp_lg_u32 s61, 0
    s_cbranch_scc1 L_lw_91
L_lwe_92:
    v_lshlrev_b32 v9, 4, v1
    v_add_u32 v9, 131072, v9
    ds_write_b128 v9, v[160:163]
    s_mov_b32 s61, 1048576
L_lw_93:
    ds_read_b32 v4, v2
    s_waitcnt lgkmcnt(0)
    v_cmp_gt_u32 vcc, s42, v4
    s_cbranch_vccz L_lwe_94
    s_sleep 2
    s_sub_u32 s61, s61, 1
    s_cmp_lg_u32 s61, 0
    s_cbranch_scc1 L_lw_93
L_lwe_94:
    s_mov_b32 s43, 0
    s_mov_b32 s52, 64528
    s_mov_b32 s53, 64544
    s_setprio 3
    s_mov_b32 s48, 262144
    s_mov_b32 s59, 0
    s_branch L_p3l_got
L_p3l_poll:
    buffer_load_dwordx2 v[10:11], v8, s[24:27], s40 offen sc1
    buffer_load_dword v5, off, s[24:27], s41 sc1
L_p3l_got:
    s_waitcnt vmcnt(0)
    v_and_b32 v10, v10, v11
    v_cmp_eq_u32 vcc, 1, v10
    v_readfirstlane_b32 s60, v5
    s_nop 1
    s_and_b32 s54, vcc_lo, vcc_hi
    s_lshr_b32 s55, s54, 16
    s_and_b32 s54, s54, s55
    s_lshr_b32 s55, s54, 1
    s_and_b32 s54, s54, s55
    s_and_b32 s54, s54, 0x5555
    s_cmp_ge_u32 s60, 56
    s_cbranch_scc1 L_p3l_y
    s_sleep 2
    s_sub_u32 s48, s48, 1
    s_cmp_lg_u32 s48, 0
    s_cbranch_scc1 L_p3l_poll
L_p3l_y:
    v_mov_b32 v12, 64524
    s_mov_b64 exec, 1
    ds_write_b32 v12, v3
    s_mov_b64 exec, -1
    s_andn2_b32 s54, s54, s43
    s_or_b32 s43, s43, s54
    s_and_b32 s58, s63, 7
    s_lshl_b32 s58, s58, 1
    s_lshl_b32 s55, s54, 16
    s_or_b32 s54, s54, s55
    s_lshr_b32 s54, s54, s58
    s_and_b32 s54, s54, 0xffff
L_p3l_next:
    s_cmp_eq_u32 s54, 0
    s_cbranch_scc1 L_p3l_none
    s_ff1_i32_b32 s55, s54
    s_bitset0_b32 s54, s55
    s_add_u32 s55, s55, s58
    s_and_b32 s55, s55, 15
    s_lshr_b32 s35, s55, 1
    s_and_b32 s35, s35, 7
    s_add_u32 s35, s35, 1
    v_mov_b32 v9, s35
    s_cmp_ge_u32 s55, 64
    s_cbranch_scc1 L_p3l_hi
    v_mov_b32 v12, s52
    s_add_u32 s52, s52, 4
    s_branch L_p3l_w
L_p3l_hi:
    v_mov_b32 v12, s53
    s_add_u32 s53, s53, 4
L_p3l_w:
    s_mov_b64 exec, 1
    ds_write_b32 v12, v9
    s_mov_b64 exec, -1
    s_branch L_p3l_next
L_p3l_none:
    s_cmp_eq_u32 s43, 0x5555
    s_cbranch_scc1 L_moe_done
    s_mov_b32 s61, 1048576
L_lw_95:
    ds_read_b32 v4, v6
    s_waitcnt lgkmcnt(0)
    v_cmp_gt_u32 vcc, 152, v4
    s_cbranch_vccz L_lwe_96
    s_sleep 2
    s_sub_u32 s61, s61, 1
    s_cmp_lg_u32 s61, 0
    s_cbranch_scc1 L_lw_95
L_lwe_96:
    s_sleep 2
    s_sub_u32 s48, s48, 1
    s_cmp_lg_u32 s48, 0
    s_cbranch_scc1 L_p3l_poll
L_moe_done:
    s_waitcnt vmcnt(0) lgkmcnt(0)
    s_branch L_done
L_c_all:
L_end:
    s_endpgm
.section .rodata,"a"
.p2align 6
.amdhsa_kernel recurrent_scan__softmax_full_mha__moe_arch_mod__prompt_kernel
  .amdhsa_next_free_vgpr 168
  .amdhsa_next_free_sgpr 96
  .amdhsa_accum_offset 168
  .amdhsa_group_segment_fixed_size 0
  .amdhsa_kernarg_size 88
  .amdhsa_user_sgpr_count 2
  .amdhsa_user_sgpr_kernarg_segment_ptr 1
  .amdhsa_system_sgpr_workgroup_id_x 1
.end_amdhsa_kernel
```
